```python
import torch

def _softmax(x, axis=-1):
    return torch.softmax(x, dim=axis)
def _gelu(x):
    return torch.nn.functional.gelu(x, approximate="tanh")
def _silu(x):
    return torch.nn.functional.silu(x)
def _sigmoid(x):
    return torch.sigmoid(x)
def _layernorm(x, axis=-1, eps=1e-5):
    m = x.mean(dim=axis, keepdim=True)
    v = x.var(dim=axis, keepdim=True, unbiased=False)
    return (x - m) / torch.sqrt(v + eps)
def _scatter_add(tgt, idx, src, axis=0):
    return tgt.clone().index_add_(axis, idx, src)
def _segment_sum(src, seg, n):
    out = torch.zeros((n,) + src.shape[1:], dtype=src.dtype)
    return out.index_add_(0, seg, src)
def _pad(x, pw):
    flat = tuple(v for pair in reversed(pw) for v in pair)
    return torch.nn.functional.pad(x, flat)

kernel_name = 'standalone__detection_seg_dino__vision'

def setup_inputs():

    _w = (lambda a: (lambda t: t.to(torch.bfloat16) if t.is_floating_point() else t)(torch.as_tensor(a)))
    H = W = (224 // 2) * 2
    C = 192
    Nq = 16
    sc = C ** -0.5
    return {
        "q": _w((lambda *s: torch.randn(*s, dtype=torch.bfloat16) * 0.05)(1, Nq, C)),
        "f0": _w((lambda *s: torch.randn(*s, dtype=torch.bfloat16) * 0.8)(1, H, W, C)),
        "f1": _w((lambda *s: torch.randn(*s, dtype=torch.bfloat16) * 0.8)(1, H // 2, W // 2, C)),
        "wq": _w((lambda *s: torch.randn(*s, dtype=torch.bfloat16) * 1.6)(C, C) * sc),
        "wk": _w((lambda *s: torch.randn(*s, dtype=torch.bfloat16) * 1.6)(C, C) * sc),
        "wv": _w((lambda *s: torch.randn(*s, dtype=torch.bfloat16) * 0.8)(C, C) * sc),
        "wo": _w((lambda *s: torch.randn(*s, dtype=torch.bfloat16) * 0.8)(C, C) * sc),
    }

def reference(q, f0, f1, wq, wk, wv, wo):
    B, H, W, C = f0.shape
    f1u = (lambda x, n, axis: torch.repeat_interleave(x, n, dim=axis))((lambda x, n, axis: torch.repeat_interleave(x, n, dim=axis))(f1, 2, axis=1), 2, axis=2)
    fused = f0 + f1u
    feats = _layernorm(fused.reshape(B, H * W, C), axis=-1)
    qn = _layernorm(q, axis=-1)
    Q = torch.einsum("bnc,cd->bnd", qn, wq)
    K = torch.einsum("bmc,cd->bmd", feats, wk)
    V = torch.einsum("bmc,cd->bmd", feats, wv)
    scale = C ** -0.5
    logits = torch.einsum("bnd,bmd->bnm", Q, K) * scale
    attn = _softmax(logits, axis=-1)
    ctx = torch.einsum("bnm,bmd->bnd", attn, V)
    return q + torch.einsum("bnd,dc->bnc", ctx, wo)
```

```asm
; @launch grid=(256,1,1) block=(512,1,1) lds=125408
.amdgcn_target "amdgcn-amd-amdhsa--gfx950"
.text
.globl standalone__detection_seg_dino__vision_kernel
.p2align 8
.type standalone__detection_seg_dino__vision_kernel,@function
standalone__detection_seg_dino__vision_kernel:
    s_cmp_ge_u32 s2, 256
    s_cbranch_scc1 L_exit
    s_load_dwordx16 s[8:23], s[0:1], 0
    s_load_dwordx4 s[24:27], s[0:1], 64
    v_and_b32 v1, 63, v0
    v_lshrrev_b32 v4, 6, v0
    v_and_b32 v2, 15, v1
    v_readfirstlane_b32 s28, v4
    v_lshrrev_b32 v3, 4, v1
    s_mov_b32 s58, 0
    s_mov_b64 s[56:57], -1
    s_waitcnt lgkmcnt(0)
    s_and_b32 s31, s2, 7
    s_cmp_eq_u32 s31, 0
    s_cbranch_scc1 L_helpers
    s_lshr_b32 s53, s2, 3
    s_sub_u32 s30, s2, s53
    s_sub_u32 s30, s30, 1
    s_mul_i32 s32, s53, 37
    s_lshr_b32 s32, s32, 8
    s_mul_i32 s32, s32, 7
    s_sub_u32 s32, s53, s32
    s_add_u32 s32, s32, 1
    s_cmp_eq_u32 s32, s31
    s_cselect_b32 s54, 1, 0
    s_cmp_eq_u32 s28, 7
    s_cbranch_scc1 L_helper_1
    s_lshr_b32 s31, s30, 1
    s_and_b32 s32, s30, 1
    s_mul_i32 s32, s32, 56
    s_lshl_b32 s33, s28, 3
    s_add_u32 s32, s32, s33
    s_mul_i32 s33, s31, 112
    s_add_u32 s33, s33, s32
    s_mul_i32 s33, s33, 384
    s_add_u32 s34, s12, s33
    s_addc_u32 s35, s13, 0
    s_mul_i32 s33, s31, 448
    s_lshl_b32 s32, s32, 1
    s_add_u32 s33, s33, s32
    s_mul_i32 s33, s33, 384
    s_add_u32 s36, s10, s33
    s_addc_u32 s37, s11, 0
    s_add_u32 s38, s36, 86016
    s_addc_u32 s39, s37, 0
    s_mul_i32 s43, s28, 15392
    s_add_u32 s43, s43, 17664
    s_movk_i32 s44, 2731
    v_add_u32 v176, 0, v1
    v_mul_u32_u24 v177, s44, v176
    v_lshrrev_b32 v177, 16, v177
    v_mul_u32_u24 v178, 24, v177
    v_sub_u32 v176, v176, v178
    v_bfe_u32 v178, v177, 1, 1
    v_bfe_u32 v179, v177, 2, 1
    v_lshl_add_u32 v178, v178, 2, v179
    v_xor_b32 v178, v178, v176
    v_mul_u32_u24 v179, 384, v177
    v_lshl_add_u32 v4, v178, 4, v179
    s_add_u32 m0, s43, 0
    s_nop 0
    global_load_lds_dwordx4 v4, s[34:35] nt
    v_add_u32 v180, 64, v1
    v_mul_u32_u24 v181, s44, v180
    v_lshrrev_b32 v181, 16, v181
    v_mul_u32_u24 v182, 24, v181
    v_sub_u32 v180, v180, v182
    v_bfe_u32 v182, v181, 1, 1
    v_bfe_u32 v183, v181, 2, 1
    v_lshl_add_u32 v182, v182, 2, v183
    v_xor_b32 v182, v182, v180
    v_mul_u32_u24 v183, 384, v181
    v_lshl_add_u32 v5, v182, 4, v183
    s_add_u32 m0, s43, 1024
    s_nop 0
    global_load_lds_dwordx4 v5, s[34:35] nt
    v_add_u32 v184, 128, v1
    v_mul_u32_u24 v185, s44, v184
    v_lshrrev_b32 v185, 16, v185
    v_mul_u32_u24 v186, 24, v185
    v_sub_u32 v184, v184, v186
    v_bfe_u32 v186, v185, 1, 1
    v_bfe_u32 v187, v185, 2, 1
    v_lshl_add_u32 v186, v186, 2, v187
    v_xor_b32 v186, v186, v184
    v_mul_u32_u24 v187, 384, v185
    v_lshl_add_u32 v6, v186, 4, v187
    s_add_u32 m0, s43, 2048
    s_nop 0
    global_load_lds_dwordx4 v6, s[34:35] nt
    v_bfe_u32 v178, v177, 1, 2
    v_lshlrev_b32 v178, 1, v178
    v_xor_b32 v178, v178, v176
    v_lshl_add_u32 v191, v178, 4, v179
    v_xor_b32 v194, 16, v191
    v_bfe_u32 v182, v181, 1, 2
    v_lshlrev_b32 v182, 1, v182
    v_xor_b32 v182, v182, v180
    v_lshl_add_u32 v192, v182, 4, v183
    v_xor_b32 v195, 16, v192
    v_bfe_u32 v186, v185, 1, 2
    v_lshlrev_b32 v186, 1, v186
    v_xor_b32 v186, v186, v184
    v_lshl_add_u32 v193, v186, 4, v187
    v_xor_b32 v196, 16, v193
    s_add_u32 m0, s43, 3072
    s_nop 0
    global_load_lds_dwordx4 v191, s[36:37] nt
    s_add_u32 m0, s43, 4096
    s_nop 0
    global_load_lds_dwordx4 v192, s[36:37] nt
    s_add_u32 m0, s43, 5120
    s_nop 0
    global_load_lds_dwordx4 v193, s[36:37] nt
    s_add_u32 m0, s43, 3072
    s_nop 0
    global_load_lds_dwordx4 v194, s[36:37] offset:3072 nt
    s_add_u32 m0, s43, 4096
    s_nop 0
    global_load_lds_dwordx4 v195, s[36:37] offset:3072 nt
    s_add_u32 m0, s43, 5120
    s_nop 0
    global_load_lds_dwordx4 v196, s[36:37] offset:3072 nt
    s_add_u32 m0, s43, 9216
    s_nop 0
    global_load_lds_dwordx4 v191, s[38:39] nt
    s_add_u32 m0, s43, 10240
    s_nop 0
    global_load_lds_dwordx4 v192, s[38:39] nt
    s_add_u32 m0, s43, 11264
    s_nop 0
    global_load_lds_dwordx4 v193, s[38:39] nt
    v_and_b32 v176, 1, v3
    v_lshlrev_b32 v176, 1, v176
    v_lshrrev_b32 v177, 1, v3
    v_or_b32 v176, v176, v177
    v_bfe_u32 v177, v2, 1, 2
    v_lshlrev_b32 v177, 1, v177
    v_lshrrev_b32 v178, 3, v2
    v_or_b32 v177, v177, v178
    v_xor_b32 v177, v177, v176
    v_mul_u32_u24 v179, 384, v2
    v_add_u32 v179, s43, v179
    v_lshl_add_u32 v13, v177, 4, v179
    v_xor_b32 v177, 4, v177
    v_lshl_add_u32 v14, v177, 4, v179
    v_bfe_u32 v177, v2, 2, 1
    v_lshlrev_b32 v177, 2, v177
    v_lshrrev_b32 v178, 3, v2
    v_or_b32 v177, v177, v178
    v_xor_b32 v177, v177, v176
    v_lshrrev_b32 v178, 1, v2
    v_mul_u32_u24 v178, 384, v178
    v_add_u32 v178, s43, v178
    v_lshl_add_u32 v16, v177, 4, v178
    v_xor_b32 v177, 4, v177
    v_lshl_add_u32 v15, v177, 4, v178
    v_mov_b32 v17, 1.0
    v_lshlrev_b32 v18, 4, v1
    v_lshlrev_b32 v19, 5, v2
    v_mov_b32 v20, 0x3f803f80
    v_mov_b32 v21, 0x3f803f80
    v_mov_b32 v22, 0x3f803f80
    v_mov_b32 v23, 0x3f803f80
    v_mul_u32_u24 v199, 400, v2
    v_lshl_add_u32 v199, v176, 4, v199
    v_mov_b32 v140, 0
    v_mov_b32 v141, 0
    v_mov_b32 v142, 0
    v_mov_b32 v143, 0
    v_mov_b32 v144, 0
    v_mov_b32 v145, 0
    v_mov_b32 v146, 0
    v_mov_b32 v147, 0
    v_bfe_u32 v176, v1, 2, 4
    v_bfe_u32 v177, v176, 1, 2
    v_lshlrev_b32 v177, 1, v177
    v_lshrrev_b32 v178, 3, v176
    v_or_b32 v177, v177, v178
    v_bfe_u32 v178, v1, 1, 1
    s_and_b32 s44, s28, 1
    s_lshl_b32 s44, s44, 2
    v_or_b32 v178, s44, v178
    v_xor_b32 v177, v177, v178
    v_mul_u32_u24 v179, 384, v176
    v_and_b32 v180, 1, v1
    v_lshl_add_u32 v179, v180, 3, v179
    s_lshr_b32 s45, s28, 1
    s_lshl_b32 s45, s45, 7
    s_add_u32 s45, s45, 17664
    v_add_u32 v179, s45, v179
    v_lshl_add_u32 v4, v177, 4, v179
    v_xor_b32 v177, 2, v177
    v_lshl_add_u32 v5, v177, 4, v179
    v_add_u32 v6, 61568, v4
    v_add_u32 v7, 61568, v5
    v_and_b32 v176, 1, v3
    v_lshlrev_b32 v176, 2, v176
    v_lshrrev_b32 v177, 1, v3
    v_or_b32 v176, v176, v177
    v_xor_b32 v176, v176, v178
    v_bfe_u32 v177, v1, 2, 1
    v_lshl_add_u32 v177, v3, 1, v177
    v_mul_u32_u24 v177, 384, v177
    v_lshl_add_u32 v177, v180, 3, v177
    v_add_u32 v177, s45, v177
    v_bfe_u32 v179, v1, 3, 1
    v_mul_u32_u24 v179, 15392, v179
    v_add_u32 v179, v179, v177
    v_lshl_add_u32 v8, v176, 4, v179
    v_xor_b32 v176, 2, v176
    v_lshl_add_u32 v9, v176, 4, v179
    v_add_u32 v10, 61568, v8
    v_add_u32 v11, 61568, v9
    v_lshl_add_u32 v188, v176, 4, v177
    v_xor_b32 v176, 2, v176
    v_lshl_add_u32 v12, v176, 4, v177
    v_add_u32 v12, 92352, v12
    v_add_u32 v188, 92352, v188
    s_lshl_b32 s46, s28, 10
    v_add_u32 v252, s46, v18
    v_add_u32 v253, 8192, v252
    v_add_u32 v254, 16384, v252
    s_lshr_b32 s46, s28, 1
    s_mul_i32 s46, s46, 12
    v_mov_b32 v255, s46
    s_mov_b32 s44, 0x3baaaaab
    s_mov_b32 s45, 0x3727c5ac
    s_waitcnt vmcnt(9)
    s_add_u32 m0, s43, 9216
    s_nop 0
    global_load_lds_dwordx4 v194, s[38:39] offset:3072 nt
    s_add_u32 m0, s43, 10240
    s_nop 0
    global_load_lds_dwordx4 v195, s[38:39] offset:3072 nt
    s_add_u32 m0, s43, 11264
    s_nop 0
    global_load_lds_dwordx4 v196, s[38:39] offset:3072 nt
    ds_read_b128 v[24:27], v16 offset:0
    ds_read_b128 v[28:31], v15 offset:0
    ds_read_b128 v[32:35], v16 offset:128
    ds_read_b128 v[36:39], v15 offset:128
    ds_read_b128 v[40:43], v16 offset:256
    ds_read_b128 v[44:47], v15 offset:256
    s_waitcnt lgkmcnt(5)
    v_mfma_f32_16x16x32_bf16 v[120:123], v[24:27], v[20:23], 0
    s_waitcnt lgkmcnt(4)
    v_mfma_f32_16x16x32_bf16 v[120:123], v[28:31], v[20:23], v[120:123]
    s_waitcnt lgkmcnt(3)
    v_mfma_f32_16x16x32_bf16 v[120:123], v[32:35], v[20:23], v[120:123]
    s_waitcnt lgkmcnt(2)
    v_mfma_f32_16x16x32_bf16 v[120:123], v[36:39], v[20:23], v[120:123]
    s_waitcnt lgkmcnt(1)
    v_mfma_f32_16x16x32_bf16 v[120:123], v[40:43], v[20:23], v[120:123]
    s_waitcnt lgkmcnt(0)
    v_mfma_f32_16x16x32_bf16 v[120:123], v[44:47], v[20:23], v[120:123]
    v_dot2c_f32_bf16 v140, v24, v24
    v_dot2c_f32_bf16 v141, v25, v25
    v_dot2c_f32_bf16 v140, v26, v26
    v_dot2c_f32_bf16 v141, v27, v27
    v_dot2c_f32_bf16 v140, v28, v28
    v_dot2c_f32_bf16 v141, v29, v29
    v_dot2c_f32_bf16 v140, v30, v30
    v_dot2c_f32_bf16 v141, v31, v31
    v_dot2c_f32_bf16 v140, v32, v32
    v_dot2c_f32_bf16 v141, v33, v33
    v_dot2c_f32_bf16 v140, v34, v34
    v_dot2c_f32_bf16 v141, v35, v35
    v_dot2c_f32_bf16 v140, v36, v36
    v_dot2c_f32_bf16 v141, v37, v37
    v_dot2c_f32_bf16 v140, v38, v38
    v_dot2c_f32_bf16 v141, v39, v39
    v_dot2c_f32_bf16 v140, v40, v40
    v_dot2c_f32_bf16 v141, v41, v41
    v_dot2c_f32_bf16 v140, v42, v42
    v_dot2c_f32_bf16 v141, v43, v43
    v_dot2c_f32_bf16 v140, v44, v44
    v_dot2c_f32_bf16 v141, v45, v45
    v_dot2c_f32_bf16 v140, v46, v46
    v_dot2c_f32_bf16 v141, v47, v47
    s_nop 2
    v_add_f32 v140, v140, v141
    v_mov_b32 v164, v120
    v_mov_b32 v165, v121
    v_mov_b32 v166, v122
    v_mov_b32 v167, v123
    v_mul_f32 v120, s44, v120
    v_mul_f32 v121, s44, v121
    v_mul_f32 v122, s44, v122
    v_mul_f32 v123, s44, v123
    v_mov_b32 v197, v120
    v_mov_b32 v198, v122
    s_waitcnt vmcnt(6)
    ds_read_b128 v[48:51], v13 offset:3072
    ds_read_b128 v[52:55], v14 offset:3072
    ds_read_b128 v[56:59], v13 offset:3200
    ds_read_b128 v[60:63], v14 offset:3200
    ds_read_b128 v[64:67], v13 offset:3328
    ds_read_b128 v[68:71], v14 offset:3328
    s_waitcnt lgkmcnt(5)
    v_mfma_f32_16x16x32_bf16 v[124:127], v[48:51], v[20:23], v[164:167]
    s_waitcnt lgkmcnt(4)
    v_mfma_f32_16x16x32_bf16 v[124:127], v[52:55], v[20:23], v[124:127]
    s_waitcnt lgkmcnt(3)
    v_mfma_f32_16x16x32_bf16 v[124:127], v[56:59], v[20:23], v[124:127]
    s_waitcnt lgkmcnt(2)
    v_mfma_f32_16x16x32_bf16 v[124:127], v[60:63], v[20:23], v[124:127]
    s_waitcnt lgkmcnt(1)
    v_mfma_f32_16x16x32_bf16 v[124:127], v[64:67], v[20:23], v[124:127]
    s_waitcnt lgkmcnt(0)
    v_mfma_f32_16x16x32_bf16 v[124:127], v[68:71], v[20:23], v[124:127]
    v_dot2c_f32_bf16 v142, v48, v48
    v_dot2c_f32_bf16 v144, v48, v24
    v_dot2c_f32_bf16 v143, v49, v49
    v_dot2c_f32_bf16 v145, v49, v25
    v_dot2c_f32_bf16 v142, v50, v50
    v_dot2c_f32_bf16 v144, v50, v26
    v_dot2c_f32_bf16 v143, v51, v51
    v_dot2c_f32_bf16 v145, v51, v27
    v_dot2c_f32_bf16 v142, v52, v52
    v_dot2c_f32_bf16 v144, v52, v28
    v_dot2c_f32_bf16 v143, v53, v53
    v_dot2c_f32_bf16 v145, v53, v29
    v_dot2c_f32_bf16 v142, v54, v54
    v_dot2c_f32_bf16 v144, v54, v30
    v_dot2c_f32_bf16 v143, v55, v55
    v_dot2c_f32_bf16 v145, v55, v31
    v_dot2c_f32_bf16 v142, v56, v56
    v_dot2c_f32_bf16 v144, v56, v32
    v_dot2c_f32_bf16 v143, v57, v57
    v_dot2c_f32_bf16 v145, v57, v33
    v_dot2c_f32_bf16 v142, v58, v58
    v_dot2c_f32_bf16 v144, v58, v34
    v_dot2c_f32_bf16 v143, v59, v59
    v_dot2c_f32_bf16 v145, v59, v35
    v_dot2c_f32_bf16 v142, v60, v60
    v_dot2c_f32_bf16 v144, v60, v36
    v_dot2c_f32_bf16 v143, v61, v61
    v_dot2c_f32_bf16 v145, v61, v37
    v_dot2c_f32_bf16 v142, v62, v62
    v_dot2c_f32_bf16 v144, v62, v38
    v_dot2c_f32_bf16 v143, v63, v63
    v_dot2c_f32_bf16 v145, v63, v39
    v_dot2c_f32_bf16 v142, v64, v64
    v_dot2c_f32_bf16 v144, v64, v40
    v_dot2c_f32_bf16 v143, v65, v65
    v_dot2c_f32_bf16 v145, v65, v41
    v_dot2c_f32_bf16 v142, v66, v66
    v_dot2c_f32_bf16 v144, v66, v42
    v_dot2c_f32_bf16 v143, v67, v67
    v_dot2c_f32_bf16 v145, v67, v43
    v_dot2c_f32_bf16 v142, v68, v68
    v_dot2c_f32_bf16 v144, v68, v44
    v_dot2c_f32_bf16 v143, v69, v69
    v_dot2c_f32_bf16 v145, v69, v45
    v_dot2c_f32_bf16 v142, v70, v70
    v_dot2c_f32_bf16 v144, v70, v46
    v_dot2c_f32_bf16 v143, v71, v71
    v_dot2c_f32_bf16 v145, v71, v47
    s_nop 1
    v_add_f32 v142, v142, v143
    v_add_f32 v144, v144, v145
    v_add_f32 v142, v142, v140
    v_fma_f32 v142, 2.0, v144, v142
    s_nop 1
    v_mfma_f32_16x16x4_f32 v[132:135], v142, v17, 0
    v_mov_b32 v142, 0
    v_mov_b32 v143, 0
    v_mov_b32 v144, 0
    v_mov_b32 v145, 0
    v_mul_f32 v124, s44, v124
    v_mul_f32 v125, s44, v125
    v_mul_f32 v126, s44, v126
    v_mul_f32 v127, s44, v127
    v_mul_f32 v176, v124, v124
    v_mul_f32 v177, v125, v125
    v_mul_f32 v178, v126, v126
    v_mul_f32 v179, v127, v127
    v_fma_f32 v132, v132, s44, -v176
    v_fma_f32 v133, v133, s44, -v177
    v_fma_f32 v134, v134, s44, -v178
    v_fma_f32 v135, v135, s44, -v179
    v_max_f32 v132, 0, v132
    v_max_f32 v133, 0, v133
    v_max_f32 v134, 0, v134
    v_max_f32 v135, 0, v135
    v_add_f32 v132, s45, v132
    v_add_f32 v133, s45, v133
    v_add_f32 v134, s45, v134
    v_add_f32 v135, s45, v135
    v_rsq_f32 v148, v132
    v_rsq_f32 v149, v133
    v_rsq_f32 v150, v134
    v_rsq_f32 v151, v135
    v_sub_f32 v244, v124, v120
    v_sub_f32 v245, v125, v121
    v_sub_f32 v246, v126, v122
    v_sub_f32 v247, v127, v123
    v_mul_f32 v156, v124, v148
    v_mul_f32 v157, v125, v149
    v_mul_f32 v158, v126, v150
    v_mul_f32 v159, v127, v151
    s_waitcnt vmcnt(3)
    global_load_dwordx3 v[212:214], v255, s[24:25] sc1
    global_load_dwordx4 v[200:203], v252, s[26:27] sc1
    global_load_dwordx4 v[204:207], v253, s[26:27] sc1
    global_load_dwordx4 v[208:211], v254, s[26:27] sc1
    s_cmp_lg_u32 s28, 6
    s_cbranch_scc1 L_w6q_2
    s_lshl_b32 s46, 7, 10
    v_add_u32 v184, s46, v18
    v_add_u32 v185, 8192, v184
    v_add_u32 v186, 16384, v184
    s_lshr_b32 s46, 7, 1
    s_mul_i32 s46, s46, 12
    v_mov_b32 v187, s46
    global_load_dwordx3 v[240:242], v187, s[24:25] sc1
    global_load_dwordx4 v[228:231], v184, s[26:27] sc1
    global_load_dwordx4 v[232:235], v185, s[26:27] sc1
    global_load_dwordx4 v[236:239], v186, s[26:27] sc1
L_w6q_2:
    s_cmp_lg_u32 s28, 6
    s_cbranch_scc1 L_w6w_3
    s_waitcnt vmcnt(8)
    s_branch L_w6w_4
L_w6w_3:
    s_waitcnt vmcnt(4)
L_w6w_4:
    ds_read_b128 v[72:75], v13 offset:9216
    ds_read_b128 v[76:79], v14 offset:9216
    ds_read_b128 v[80:83], v13 offset:9344
    ds_read_b128 v[84:87], v14 offset:9344
    ds_read_b128 v[88:91], v13 offset:9472
    ds_read_b128 v[92:95], v14 offset:9472
    s_waitcnt lgkmcnt(5)
    v_mfma_f32_16x16x32_bf16 v[128:131], v[72:75], v[20:23], v[164:167]
    s_waitcnt lgkmcnt(4)
    v_mfma_f32_16x16x32_bf16 v[128:131], v[76:79], v[20:23], v[128:131]
    s_waitcnt lgkmcnt(3)
    v_mfma_f32_16x16x32_bf16 v[128:131], v[80:83], v[20:23], v[128:131]
    s_waitcnt lgkmcnt(2)
    v_mfma_f32_16x16x32_bf16 v[128:131], v[84:87], v[20:23], v[128:131]
    s_waitcnt lgkmcnt(1)
    v_mfma_f32_16x16x32_bf16 v[128:131], v[88:91], v[20:23], v[128:131]
    s_waitcnt lgkmcnt(0)
    v_mfma_f32_16x16x32_bf16 v[128:131], v[92:95], v[20:23], v[128:131]
    v_dot2c_f32_bf16 v142, v72, v72
    v_dot2c_f32_bf16 v144, v72, v24
    v_dot2c_f32_bf16 v143, v73, v73
    v_dot2c_f32_bf16 v145, v73, v25
    v_dot2c_f32_bf16 v142, v74, v74
    v_dot2c_f32_bf16 v144, v74, v26
    v_dot2c_f32_bf16 v143, v75, v75
    v_dot2c_f32_bf16 v145, v75, v27
    v_dot2c_f32_bf16 v142, v76, v76
    v_dot2c_f32_bf16 v144, v76, v28
    v_dot2c_f32_bf16 v143, v77, v77
    v_dot2c_f32_bf16 v145, v77, v29
    v_dot2c_f32_bf16 v142, v78, v78
    v_dot2c_f32_bf16 v144, v78, v30
    v_dot2c_f32_bf16 v143, v79, v79
    v_dot2c_f32_bf16 v145, v79, v31
    v_dot2c_f32_bf16 v142, v80, v80
    v_dot2c_f32_bf16 v144, v80, v32
    v_dot2c_f32_bf16 v143, v81, v81
    v_dot2c_f32_bf16 v145, v81, v33
    v_dot2c_f32_bf16 v142, v82, v82
    v_dot2c_f32_bf16 v144, v82, v34
    v_dot2c_f32_bf16 v143, v83, v83
    v_dot2c_f32_bf16 v145, v83, v35
    v_dot2c_f32_bf16 v142, v84, v84
    v_dot2c_f32_bf16 v144, v84, v36
    v_dot2c_f32_bf16 v143, v85, v85
    v_dot2c_f32_bf16 v145, v85, v37
    v_dot2c_f32_bf16 v142, v86, v86
    v_dot2c_f32_bf16 v144, v86, v38
    v_dot2c_f32_bf16 v143, v87, v87
    v_dot2c_f32_bf16 v145, v87, v39
    v_dot2c_f32_bf16 v142, v88, v88
    v_dot2c_f32_bf16 v144, v88, v40
    v_dot2c_f32_bf16 v143, v89, v89
    v_dot2c_f32_bf16 v145, v89, v41
    v_dot2c_f32_bf16 v142, v90, v90
    v_dot2c_f32_bf16 v144, v90, v42
    v_dot2c_f32_bf16 v143, v91, v91
    v_dot2c_f32_bf16 v145, v91, v43
    v_dot2c_f32_bf16 v142, v92, v92
    v_dot2c_f32_bf16 v144, v92, v44
    v_dot2c_f32_bf16 v143, v93, v93
    v_dot2c_f32_bf16 v145, v93, v45
    v_dot2c_f32_bf16 v142, v94, v94
    v_dot2c_f32_bf16 v144, v94, v46
    v_dot2c_f32_bf16 v143, v95, v95
    v_dot2c_f32_bf16 v145, v95, v47
    s_nop 1
    v_add_f32 v142, v142, v143
    v_add_f32 v144, v144, v145
    v_add_f32 v142, v142, v140
    v_fma_f32 v142, 2.0, v144, v142
    s_nop 1
    v_mfma_f32_16x16x4_f32 v[136:139], v142, v17, 0
    v_mul_f32 v128, s44, v128
    v_mul_f32 v129, s44, v129
    v_mul_f32 v130, s44, v130
    v_mul_f32 v131, s44, v131
    v_mul_f32 v176, v128, v128
    v_mul_f32 v177, v129, v129
    v_mul_f32 v178, v130, v130
    v_mul_f32 v179, v131, v131
    s_nop 1
    v_fma_f32 v136, v136, s44, -v176
    v_fma_f32 v137, v137, s44, -v177
    v_fma_f32 v138, v138, s44, -v178
    v_fma_f32 v139, v139, s44, -v179
    v_max_f32 v136, 0, v136
    v_max_f32 v137, 0, v137
    v_max_f32 v138, 0, v138
    v_max_f32 v139, 0, v139
    v_add_f32 v136, s45, v136
    v_add_f32 v137, s45, v137
    v_add_f32 v138, s45, v138
    v_add_f32 v139, s45, v139
    v_rsq_f32 v152, v136
    v_rsq_f32 v153, v137
    v_rsq_f32 v154, v138
    v_rsq_f32 v155, v139
    v_sub_f32 v248, v128, v120
    v_sub_f32 v249, v129, v121
    v_sub_f32 v250, v130, v122
    v_sub_f32 v251, v131, v123
    v_mul_f32 v160, v128, v152
    v_mul_f32 v161, v129, v153
    v_mul_f32 v162, v130, v154
    v_mul_f32 v163, v131, v155
    s_mov_b32 s42, 0
    s_nop 1
L_qretry_5:
    s_waitcnt vmcnt(0)
    v_xor_b32 v216, v203, v212
    v_xor_b32 v217, v207, v213
    v_xor_b32 v218, v211, v214
    v_or3_b32 v216, v216, v217, v218
    v_min3_u32 v217, v212, v213, v214
    v_cmp_eq_u32 vcc, 0, v217
    s_nop 1
    v_cndmask_b32 v217, 0, 1, vcc
    v_or_b32 v216, v216, v217
    v_cmp_ne_u32 vcc, 0, v216
    s_nop 4
    s_cbranch_vccz L_qok_6
    s_add_u32 s42, s42, 1
    s_cmp_ge_u32 s42, 0x40000
    s_cbranch_scc1 L_qok_6
    global_load_dwordx3 v[212:214], v255, s[24:25] sc1
    global_load_dwordx4 v[200:203], v252, s[26:27] sc1
    global_load_dwordx4 v[204:207], v253, s[26:27] sc1
    global_load_dwordx4 v[208:211], v254, s[26:27] sc1
    s_branch L_qretry_5
L_qok_6:
    v_mov_b32 v225, 0x00003f80
    v_mov_b32 v226, 0x3f800000
    v_mov_b32 v227, 0x3f803f80
    v_dot2_f32_bf16 v216, v200, v225, 0
    v_dot2_f32_bf16 v217, v200, v226, 0
    v_dot2_f32_bf16 v218, v201, v225, 0
    v_dot2_f32_bf16 v219, v201, v226, 0
    v_dot2_f32_bf16 v220, v202, v225, 0
    v_dot2_f32_bf16 v221, v202, v226, 0
    v_dot2_f32_bf16 v216, v204, v225, v216
    v_dot2_f32_bf16 v217, v204, v226, v217
    v_dot2_f32_bf16 v218, v205, v225, v218
    v_dot2_f32_bf16 v219, v205, v226, v219
    v_dot2_f32_bf16 v220, v206, v225, v220
    v_dot2_f32_bf16 v221, v206, v226, v221
    v_dot2_f32_bf16 v216, v208, v225, v216
    v_dot2_f32_bf16 v217, v208, v226, v217
    v_dot2_f32_bf16 v218, v209, v225, v218
    v_dot2_f32_bf16 v219, v209, v226, v219
    v_dot2_f32_bf16 v220, v210, v225, v220
    v_dot2_f32_bf16 v221, v210, v226, v221
    v_cvt_pk_bf16_f32 v200, v216, v217
    v_cvt_pk_bf16_f32 v201, v218, v219
    s_nop 0
    v_cvt_pk_bf16_f32 v202, v220, v221
    s_and_b32 s46, s28, 1
    s_lshl_b32 s46, s46, 3
    v_lshrrev_b32 v222, 3, v1
    v_add_u32 v222, s46, v222
    v_and_b32 v223, 7, v1
    v_mul_u32_u24 v223, 12, v223
    v_mul_u32_u24 v224, 400, v222
    s_lshr_b32 s47, s28, 1
    s_mul_i32 s46, s47, 96
    s_add_u32 s46, s46, 0
    v_add3_u32 v223, v223, v224, s46
    ds_write2_b32 v223, v200, v201 offset0:0 offset1:1
    ds_write_b32 v223, v202 offset:8
    v_mov_b32 v216, 0
    v_dot2c_f32_bf16 v216, v200, v227
    v_dot2c_f32_bf16 v216, v201, v227
    v_dot2c_f32_bf16 v216, v202, v227
    s_nop 2
    v_add_f32_dpp v216, v216, v216 quad_perm:[1,0,3,2] row_mask:0xf bank_mask:0xf
    s_nop 1
    v_add_f32_dpp v216, v216, v216 quad_perm:[2,3,0,1] row_mask:0xf bank_mask:0xf
    s_nop 1
    v_add_f32_dpp v216, v216, v216 row_half_mirror row_mask:0xf bank_mask:0xf
    s_lshl_b32 s47, s47, 2
    s_add_u32 s47, s47, 15616
    v_lshl_add_u32 v222, v222, 4, s47
    s_mov_b32 exec_lo, 0x01010101
    s_mov_b32 exec_hi, 0x01010101
    ds_write_b32 v222, v216
    s_mov_b64 exec, -1
    s_cmp_lg_u32 s28, 6
    s_cbranch_scc1 L_w6f_7
    s_mov_b32 s42, 0
L_qretry_8:
    s_waitcnt vmcnt(0)
    v_xor_b32 v216, v231, v240
    v_xor_b32 v217, v235, v241
    v_xor_b32 v218, v239, v242
    v_or3_b32 v216, v216, v217, v218
    v_min3_u32 v217, v240, v241, v242
    v_cmp_eq_u32 vcc, 0, v217
    s_nop 1
    v_cndmask_b32 v217, 0, 1, vcc
    v_or_b32 v216, v216, v217
    v_cmp_ne_u32 vcc, 0, v216
    s_nop 4
    s_cbranch_vccz L_qok_9
    s_add_u32 s42, s42, 1
    s_cmp_ge_u32 s42, 0x40000
    s_cbranch_scc1 L_qok_9
    global_load_dwordx3 v[240:242], v187, s[24:25] sc1
    global_load_dwordx4 v[228:231], v184, s[26:27] sc1
    global_load_dwordx4 v[232:235], v185, s[26:27] sc1
    global_load_dwordx4 v[236:239], v186, s[26:27] sc1
    s_branch L_qretry_8
L_qok_9:
    v_mov_b32 v225, 0x00003f80
    v_mov_b32 v226, 0x3f800000
    v_mov_b32 v227, 0x3f803f80
    v_dot2_f32_bf16 v216, v228, v225, 0
    v_dot2_f32_bf16 v217, v228, v226, 0
    v_dot2_f32_bf16 v218, v229, v225, 0
    v_dot2_f32_bf16 v219, v229, v226, 0
    v_dot2_f32_bf16 v220, v230, v225, 0
    v_dot2_f32_bf16 v221, v230, v226, 0
    v_dot2_f32_bf16 v216, v232, v225, v216
    v_dot2_f32_bf16 v217, v232, v226, v217
    v_dot2_f32_bf16 v218, v233, v225, v218
    v_dot2_f32_bf16 v219, v233, v226, v219
    v_dot2_f32_bf16 v220, v234, v225, v220
    v_dot2_f32_bf16 v221, v234, v226, v221
    v_dot2_f32_bf16 v216, v236, v225, v216
    v_dot2_f32_bf16 v217, v236, v226, v217
    v_dot2_f32_bf16 v218, v237, v225, v218
    v_dot2_f32_bf16 v219, v237, v226, v219
    v_dot2_f32_bf16 v220, v238, v225, v220
    v_dot2_f32_bf16 v221, v238, v226, v221
    v_cvt_pk_bf16_f32 v228, v216, v217
    v_cvt_pk_bf16_f32 v229, v218, v219
    s_nop 0
    v_cvt_pk_bf16_f32 v230, v220, v221
    s_and_b32 s46, 7, 1
    s_lshl_b32 s46, s46, 3
    v_lshrrev_b32 v222, 3, v1
    v_add_u32 v222, s46, v222
    v_and_b32 v223, 7, v1
    v_mul_u32_u24 v223, 12, v223
    v_mul_u32_u24 v224, 400, v222
    s_lshr_b32 s47, 7, 1
    s_mul_i32 s46, s47, 96
    s_add_u32 s46, s46, 0
    v_add3_u32 v223, v223, v224, s46
    ds_write2_b32 v223, v228, v229 offset0:0 offset1:1
    ds_write_b32 v223, v230 offset:8
    v_mov_b32 v216, 0
    v_dot2c_f32_bf16 v216, v228, v227
    v_dot2c_f32_bf16 v216, v229, v227
    v_dot2c_f32_bf16 v216, v230, v227
    s_nop 2
    v_add_f32_dpp v216, v216, v216 quad_perm:[1,0,3,2] row_mask:0xf bank_mask:0xf
    s_nop 1
    v_add_f32_dpp v216, v216, v216 quad_perm:[2,3,0,1] row_mask:0xf bank_mask:0xf
    s_nop 1
    v_add_f32_dpp v216, v216, v216 row_half_mirror row_mask:0xf bank_mask:0xf
    s_lshl_b32 s47, s47, 2
    s_add_u32 s47, s47, 15616
    v_lshl_add_u32 v222, v222, 4, s47
    s_mov_b32 exec_lo, 0x01010101
    s_mov_b32 exec_hi, 0x01010101
    ds_write_b32 v222, v216
    s_mov_b64 exec, -1
L_w6f_7:
    s_waitcnt lgkmcnt(0)
    s_barrier
L_main_tail:
    v_lshlrev_b32 v177, 4, v2
    ds_read_b128 v[180:183], v177 offset:15616
    ds_read_b128 v[96:99], v199 offset:0
    ds_read_b128 v[100:103], v199 offset:64
    ds_read_b128 v[104:107], v199 offset:128
    ds_read_b128 v[108:111], v199 offset:192
    ds_read_b128 v[112:115], v199 offset:256
    ds_read_b128 v[116:119], v199 offset:320
    s_waitcnt lgkmcnt(5)
    v_mfma_f32_16x16x32_bf16 v[164:167], v[24:27], v[96:99], 0
    ds_read_b64_tr_b16 v[120:121], v4 offset:3072
    v_mfma_f32_16x16x32_bf16 v[168:171], v[48:51], v[96:99], 0
    ds_read_b64_tr_b16 v[122:123], v4 offset:9216
    v_mfma_f32_16x16x32_bf16 v[172:175], v[72:75], v[96:99], 0
    ds_read_b64_tr_b16 v[124:125], v5 offset:3072
    s_waitcnt lgkmcnt(7)
    v_mfma_f32_16x16x32_bf16 v[164:167], v[28:31], v[100:103], v[164:167]
    ds_read_b64_tr_b16 v[126:127], v5 offset:9216
    v_mfma_f32_16x16x32_bf16 v[168:171], v[52:55], v[100:103], v[168:171]
    ds_read_b64_tr_b16 v[128:129], v4 offset:18464
    v_mfma_f32_16x16x32_bf16 v[172:175], v[76:79], v[100:103], v[172:175]
    ds_read_b64_tr_b16 v[130:131], v4 offset:24608
    s_waitcnt lgkmcnt(9)
    v_mfma_f32_16x16x32_bf16 v[164:167], v[32:35], v[104:107], v[164:167]
    ds_read_b64_tr_b16 v[132:133], v5 offset:18464
    v_mfma_f32_16x16x32_bf16 v[168:171], v[56:59], v[104:107], v[168:171]
    ds_read_b64_tr_b16 v[134:135], v5 offset:24608
    v_mfma_f32_16x16x32_bf16 v[172:175], v[80:83], v[104:107], v[172:175]
    ds_read_b64_tr_b16 v[136:137], v4 offset:33856
    s_waitcnt lgkmcnt(11)
    v_mfma_f32_16x16x32_bf16 v[164:167], v[36:39], v[108:111], v[164:167]
    ds_read_b64_tr_b16 v[138:139], v4 offset:40000
    v_mfma_f32_16x16x32_bf16 v[168:171], v[60:63], v[108:111], v[168:171]
    ds_read_b64_tr_b16 v[140:141], v5 offset:33856
    v_mfma_f32_16x16x32_bf16 v[172:175], v[84:87], v[108:111], v[172:175]
    ds_read_b64_tr_b16 v[142:143], v5 offset:40000
    s_waitcnt lgkmcnt(13)
    v_mfma_f32_16x16x32_bf16 v[164:167], v[40:43], v[112:115], v[164:167]
    ds_read_b64_tr_b16 v[144:145], v4 offset:49248
    v_mfma_f32_16x16x32_bf16 v[168:171], v[64:67], v[112:115], v[168:171]
    ds_read_b64_tr_b16 v[146:147], v4 offset:55392
    v_mfma_f32_16x16x32_bf16 v[172:175], v[88:91], v[112:115], v[172:175]
    ds_read_b64_tr_b16 v[200:201], v5 offset:49248
    s_waitcnt lgkmcnt(15)
    v_mfma_f32_16x16x32_bf16 v[164:167], v[44:47], v[116:119], v[164:167]
    ds_read_b64_tr_b16 v[202:203], v5 offset:55392
    v_mfma_f32_16x16x32_bf16 v[168:171], v[68:71], v[116:119], v[168:171]
    ds_read_b64_tr_b16 v[204:205], v6 offset:3072
    v_mfma_f32_16x16x32_bf16 v[172:175], v[92:95], v[116:119], v[172:175]
    ds_read_b64_tr_b16 v[206:207], v6 offset:9216
    v_add_f32 v180, v180, v181
    v_add_f32 v182, v182, v183
    v_add_f32 v189, v180, v182
    v_mul_f32 v156, v156, v189
    v_mul_f32 v157, v157, v189
    v_mul_f32 v158, v158, v189
    v_mul_f32 v159, v159, v189
    v_mul_f32 v160, v160, v189
    v_mul_f32 v161, v161, v189
    v_mul_f32 v162, v162, v189
    v_mul_f32 v163, v163, v189
    v_add_f32 v168, v168, v164
    v_add_f32 v169, v169, v165
    v_add_f32 v170, v170, v166
    v_add_f32 v171, v171, v167
    v_add_f32 v172, v172, v164
    v_add_f32 v173, v173, v165
    v_add_f32 v174, v174, v166
    v_add_f32 v175, v175, v167
    v_fma_f32 v168, v168, v148, -v156
    v_fma_f32 v169, v169, v149, -v157
    v_fma_f32 v170, v170, v150, -v158
    v_fma_f32 v171, v171, v151, -v159
    v_fma_f32 v172, v172, v152, -v160
    v_fma_f32 v173, v173, v153, -v161
    v_fma_f32 v174, v174, v154, -v162
    v_fma_f32 v175, v175, v155, -v163
    v_max3_f32 v176, v168, v169, v170
    v_max3_f32 v177, v171, v172, v173
    v_max3_f32 v176, v176, v174, v175
    v_max_f32 v176, v176, v177
    v_mov_b32 v177, v176
    s_nop 1
    v_permlane16_swap_b32 v176, v177
    v_max_f32 v176, v176, v177
    v_mov_b32 v177, v176
    s_nop 1
    v_permlane32_swap_b32 v176, v177
    v_max_f32 v176, v176, v177
    s_lshl_b32 s46, s28, 2
    v_add_u32 v178, s46, v19
    ds_write_b32 v178, v176 offset:15872
    s_waitcnt lgkmcnt(0)
    s_nop 0
    s_cmp_lg_u32 s58, 0
    s_cbranch_scc1 L_bar_12
    s_barrier
L_bar_12:
    ds_read_b128 v[180:183], v19 offset:15872
    ds_read_b128 v[184:187], v19 offset:15888
    ds_read_b64_tr_b16 v[208:209], v7 offset:3072
    ds_read_b64_tr_b16 v[210:211], v7 offset:9216
    ds_read_b64_tr_b16 v[212:213], v6 offset:18464
    ds_read_b64_tr_b16 v[214:215], v6 offset:24608
    ds_read_b64_tr_b16 v[216:217], v7 offset:18464
    ds_read_b64_tr_b16 v[218:219], v7 offset:24608
    ds_read_b64_tr_b16 v[220:221], v6 offset:33856
    ds_read_b64_tr_b16 v[222:223], v6 offset:40000
    ds_read_b64_tr_b16 v[224:225], v7 offset:33856
    ds_read_b64_tr_b16 v[226:227], v7 offset:40000
    ds_read_b64_tr_b16 v[228:229], v8 offset:0
    ds_read_b64_tr_b16 v[230:231], v8 offset:30784
    ds_read_b64_tr_b16 v[232:233], v9 offset:0
    s_waitcnt lgkmcnt(13)
    v_max3_f32 v176, v180, v181, v182
    v_max3_f32 v177, v183, v184, v185
    v_max3_f32 v176, v176, v186, v187
    v_max_f32 v176, v176, v177
    v_ceil_f32 v176, v176
    ds_read_b64_tr_b16 v[234:235], v9 offset:30784
    ds_read_b64_tr_b16 v[236:237], v10 offset:0
    ds_read_b64_tr_b16 v[238:239], v12 offset:0
    ds_read_b64_tr_b16 v[240:241], v11 offset:0
    ds_read_b64_tr_b16 v[242:243], v188 offset:0
    v_sub_f32 v168, v168, v176
    v_sub_f32 v169, v169, v176
    v_sub_f32 v170, v170, v176
    v_sub_f32 v171, v171, v176
    v_sub_f32 v172, v172, v176
    v_sub_f32 v173, v173, v176
    v_sub_f32 v174, v174, v176
    v_sub_f32 v175, v175, v176
    v_exp_f32 v168, v168
    v_exp_f32 v169, v169
    v_exp_f32 v170, v170
    v_exp_f32 v171, v171
    v_exp_f32 v172, v172
    v_exp_f32 v173, v173
    v_exp_f32 v174, v174
    v_exp_f32 v175, v175
    v_add_f32 v176, v168, v169
    v_add_f32 v177, v170, v171
    v_add_f32 v176, v176, v172
    v_add_f32 v177, v177, v173
    v_add_f32 v176, v176, v174
    v_add_f32 v177, v177, v175
    v_mul_f32 v168, v168, v148
    v_mul_f32 v169, v169, v149
    v_mul_f32 v170, v170, v150
    v_mul_f32 v171, v171, v151
    v_mul_f32 v172, v172, v152
    v_mul_f32 v173, v173, v153
    v_mul_f32 v174, v174, v154
    v_mul_f32 v175, v175, v155
    v_add_f32 v176, v176, v177
    v_cvt_pk_bf16_f32 v180, v168, v169
    v_cvt_pk_bf16_f32 v181, v170, v171
    v_cvt_pk_bf16_f32 v182, v172, v173
    v_cvt_pk_bf16_f32 v183, v174, v175
    v_mfma_f32_16x16x4_f32 v[96:99], v17, v176, 0
    s_lshl_b32 s46, s28, 10
    v_add_u32 v179, s46, v18
    ds_write_b128 v179, v[180:183] offset:6400
    v_add_f32 v184, v168, v169
    v_add_f32 v185, v172, v173
    v_add_f32 v186, v170, v171
    v_add_f32 v187, v174, v175
    v_add_f32 v184, v184, v185
    v_add_f32 v186, v186, v187
    v_cvt_pk_bf16_f32 v184, v184, v186
    v_lshlrev_b32 v168, 16, v180
    v_and_b32 v169, 0xffff0000, v180
    v_lshlrev_b32 v170, 16, v181
    v_and_b32 v171, 0xffff0000, v181
    v_lshlrev_b32 v172, 16, v182
    v_and_b32 v173, 0xffff0000, v182
    v_lshlrev_b32 v174, 16, v183
    v_and_b32 v175, 0xffff0000, v183
    s_lshr_b32 s46, s28, 2
    s_lshl_b32 s46, s46, 10
    s_and_b32 s47, s28, 3
    s_lshl_b32 s47, s47, 2
    s_add_u32 s46, s46, s47
    v_add_u32 v179, s46, v18
    ds_write_b32 v179, v184 offset:13568
    v_lshlrev_b32 v185, 16, v184
    v_and_b32 v186, 0xffff0000, v184
    v_mul_f32 v177, v185, v197
    v_mul_f32 v178, v186, v198
    v_fmac_f32 v177, v168, v244
    v_fmac_f32 v178, v169, v245
    v_fmac_f32 v177, v170, v246
    v_fmac_f32 v178, v171, v247
    v_fmac_f32 v177, v172, v248
    v_fmac_f32 v178, v173, v249
    v_fmac_f32 v177, v174, v250
    v_fmac_f32 v178, v175, v251
    v_add_f32 v177, v177, v178
    s_nop 1
    v_mfma_f32_16x16x4_f32 v[100:103], v17, v177, 0
    s_lshl_b32 s46, s28, 2
    v_add_u32 v179, s46, v19
    ds_write_b32 v179, v96 offset:16384
    s_nop 6
    ds_write_b32 v179, v100 offset:16896
    s_waitcnt lgkmcnt(0)
    s_cmp_lg_u32 s58, 0
    s_cbranch_scc1 L_bar_13
    s_barrier
L_bar_13:
    s_cmp_ge_u32 s28, 6
    s_cbranch_scc1 L_w6_done
    s_cmp_eq_u32 s54, 0
    s_cbranch_scc1 L_nf_14
    s_and_b32 s33, s53, 1
    s_mul_i32 s33, s33, 6
    s_add_u32 s33, s33, s28
    s_mul_i32 s33, s33, 6144
    s_add_u32 s33, s33, 2097152
    v_lshl_add_u32 v172, v1, 4, s33
    v_add_u32 v173, 3072, v172
    global_load_dwordx4 v[148:151], v172, s[26:27] offset:0 sc1
    global_load_dwordx4 v[152:155], v172, s[26:27] offset:1024 sc1
    global_load_dwordx4 v[156:159], v172, s[26:27] offset:2048 sc1
    global_load_dwordx4 v[160:163], v173, s[26:27] offset:0 sc1
    global_load_dwordx4 v[164:167], v173, s[26:27] offset:1024 sc1
    global_load_dwordx4 v[168:171], v173, s[26:27] offset:2048 sc1
L_nf_14:
    ds_read_b128 v[24:27], v18 offset:6400
    ds_read_b128 v[28:31], v18 offset:7424
    ds_read_b128 v[32:35], v18 offset:8448
    ds_read_b128 v[36:39], v18 offset:9472
    ds_read_b128 v[40:43], v18 offset:10496
    ds_read_b128 v[44:47], v18 offset:11520
    ds_read_b128 v[72:75], v18 offset:12544
    ds_read_b128 v[76:79], v18 offset:13568
    ds_read_b128 v[80:83], v18 offset:14592
    ds_read_b128 v[104:107], v19 offset:16896
    ds_read_b128 v[108:111], v19 offset:16912
    v_mul_u32_u24 v176, 86016, v2
    v_and_b32 v177, 1, v3
    v_lshlrev_b32 v177, 5, v177
    v_lshrrev_b32 v178, 1, v3
    v_lshl_add_u32 v177, v178, 4, v177
    v_add_u32 v176, v176, v177
    s_mul_i32 s46, s30, 192
    s_add_u32 s46, s46, 163840
    s_cmp_ge_u32 s28, 3
    s_cselect_b32 s47, 42816, 0
    s_add_u32 s46, s46, s47
    s_lshl_b32 s47, s28, 6
    s_add_u32 s46, s46, s47
    v_add_u32 v176, s46, v176
    s_waitcnt lgkmcnt(10)
    v_mfma_f32_16x16x32_bf16 v[84:87], v[120:123], v[24:27], 0
    v_mfma_f32_16x16x32_bf16 v[88:91], v[124:127], v[24:27], 0
    s_waitcnt lgkmcnt(9)
    v_mfma_f32_16x16x32_bf16 v[84:87], v[128:131], v[28:31], v[84:87]
    v_mfma_f32_16x16x32_bf16 v[88:91], v[132:135], v[28:31], v[88:91]
    s_waitcnt lgkmcnt(8)
    v_mfma_f32_16x16x32_bf16 v[84:87], v[136:139], v[32:35], v[84:87]
    v_mfma_f32_16x16x32_bf16 v[88:91], v[140:143], v[32:35], v[88:91]
    s_waitcnt lgkmcnt(7)
    v_mfma_f32_16x16x32_bf16 v[84:87], v[144:147], v[36:39], v[84:87]
    v_mfma_f32_16x16x32_bf16 v[88:91], v[200:203], v[36:39], v[88:91]
    s_waitcnt lgkmcnt(6)
    v_mfma_f32_16x16x32_bf16 v[84:87], v[204:207], v[40:43], v[84:87]
    v_mfma_f32_16x16x32_bf16 v[88:91], v[208:211], v[40:43], v[88:91]
    s_waitcnt lgkmcnt(5)
    v_mfma_f32_16x16x32_bf16 v[84:87], v[212:215], v[44:47], v[84:87]
    v_mfma_f32_16x16x32_bf16 v[88:91], v[216:219], v[44:47], v[88:91]
    s_waitcnt lgkmcnt(4)
    v_mfma_f32_16x16x32_bf16 v[84:87], v[220:223], v[72:75], v[84:87]
    v_mfma_f32_16x16x32_bf16 v[88:91], v[224:227], v[72:75], v[88:91]
    s_waitcnt lgkmcnt(3)
    v_mfma_f32_16x16x32_bf16 v[84:87], v[228:231], v[76:79], v[84:87]
    v_mfma_f32_16x16x32_bf16 v[88:91], v[232:235], v[76:79], v[88:91]
    s_waitcnt lgkmcnt(2)
    v_mfma_f32_16x16x32_bf16 v[84:87], v[236:239], v[80:83], v[84:87]
    v_mfma_f32_16x16x32_bf16 v[88:91], v[240:243], v[80:83], v[88:91]
    s_waitcnt lgkmcnt(0)
    v_add_f32 v104, v104, v105
    v_add_f32 v106, v106, v107
    v_add_f32 v108, v108, v109
    v_add_f32 v110, v110, v111
    v_add_f32 v104, v104, v106
    v_add_f32 v108, v108, v110
    v_add_f32 v104, v104, v108
    v_sub_f32 v84, v84, v104
    v_sub_f32 v85, v85, v104
    v_sub_f32 v86, v86, v104
    v_sub_f32 v87, v87, v104
    v_sub_f32 v88, v88, v104
    v_sub_f32 v89, v89, v104
    v_sub_f32 v90, v90, v104
    v_sub_f32 v91, v91, v104
    v_cvt_pk_bf16_f32 v112, v84, v85
    v_cvt_pk_bf16_f32 v113, v86, v87
    v_cvt_pk_bf16_f32 v114, v88, v89
    v_cvt_pk_bf16_f32 v115, v90, v91
    s_nop 0
    v_permlane16_swap_b32 v112, v114
    v_permlane16_swap_b32 v113, v115
    s_nop 2
    s_cmp_lg_u32 s58, 0
    s_cbranch_scc1 L_nd_15
    global_store_dwordx4 v176, v[112:115], s[26:27] sc1
    s_nop 1
L_nd_15:
L_w6_done:
    s_cmp_lg_u32 s54, 0
    s_cbranch_scc1 L_fin_tail
    s_branch L_end
L_helper_1:
    v_lshlrev_b32 v18, 4, v1
    v_lshlrev_b32 v19, 5, v2
    v_mov_b32 v4, 0
    v_mov_b32 v5, 0xff800000
    ds_write_b32 v18, v4 offset:14604
    ds_write_b32 v19, v5 offset:15900
    ds_write_b32 v19, v4 offset:16412
    ds_write_b32 v19, v4 offset:16924
    v_mov_b32 v56, -1
    v_mov_b32 v57, -1
    v_mov_b32 v58, -1
    v_mov_b32 v59, -1
    v_min_u32 v12, 47, v1
    v_mul_u32_u24 v13, 43, v12
    v_lshrrev_b32 v13, 9, v13
    v_mul_u32_u24 v14, 12, v13
    v_sub_u32 v14, v12, v14
    v_mul_u32_u24 v13, 43008, v13
    v_lshl_add_u32 v13, v14, 4, v13
    s_mul_i32 s44, s30, 192
    s_add_u32 s44, s44, 163840
    v_add_u32 v13, s44, v13
    global_store_dwordx4 v13, v[56:59], s[26:27] sc1
    v_add_u32 v13, 172032, v13
    global_store_dwordx4 v13, v[56:59], s[26:27] sc1
    v_add_u32 v13, 172032, v13
    global_store_dwordx4 v13, v[56:59], s[26:27] sc1
    v_add_u32 v13, 172032, v13
    global_store_dwordx4 v13, v[56:59], s[26:27] sc1
    v_add_u32 v13, 172032, v13
    global_store_dwordx4 v13, v[56:59], s[26:27] sc1
    v_add_u32 v13, 172032, v13
    global_store_dwordx4 v13, v[56:59], s[26:27] sc1
    v_add_u32 v13, 172032, v13
    global_store_dwordx4 v13, v[56:59], s[26:27] sc1
    v_add_u32 v13, 172032, v13
    global_store_dwordx4 v13, v[56:59], s[26:27] sc1
    s_nop 1
    s_cmp_ge_u32 s30, 16
    s_cbranch_scc1 L_oi_16
    s_mul_i32 s44, s30, 384
    v_lshl_add_u32 v13, v1, 4, s44
    s_mov_b32 exec_lo, 0xffffff
    s_mov_b32 exec_hi, 0
    global_load_dwordx4 v[60:63], v13, s[8:9]
    s_waitcnt vmcnt(0)
    global_store_dwordx4 v13, v[60:63], s[22:23] sc1
    s_mov_b64 exec, -1
    s_nop 0
L_oi_16:
    v_mov_b32 v12, 0
    s_mov_b32 s42, 0
    s_nop 1
L_poll_17:
    global_load_dword v52, v12, s[24:25] sc1
    s_add_u32 s42, s42, 1
    s_waitcnt vmcnt(0)
    v_cmp_eq_u32 vcc, 0, v52
    s_nop 4
    s_cbranch_vccz L_polld_18
    s_sleep 2
    s_cmp_lt_u32 s42, 0x40000
    s_cbranch_scc1 L_poll_17
L_polld_18:
    v_mov_b32 v12, 17408
    ds_write_b32 v12, v52
    s_nop 1
    s_cmp_eq_u32 s54, 0
    s_cbranch_scc1 L_hnf_19
    s_mov_b32 s59, s28
    s_mov_b32 s28, 0
    s_mov_b32 s58, 1
    s_mov_b64 s[56:57], 0
    s_mov_b64 exec, 0
    s_branch L_fin_tail
L_fin_dry_ret:
    s_mov_b32 s28, s59
    s_mov_b32 s58, 0
    s_mov_b64 s[56:57], -1
    s_mov_b64 exec, -1
    s_and_b32 s33, s53, 1
    s_mul_i32 s33, s33, 6
    v_min_u32 v13, 5, v1
    v_add_u32 v13, s33, v13
    v_lshlrev_b32 v13, 7, v13
    v_add_u32 v13, 2228224, v13
    s_mov_b32 s42, 0
    s_nop 1
L_poll_20:
    global_load_dword v14, v13, s[26:27] sc1
    s_add_u32 s42, s42, 1
    s_waitcnt vmcnt(0)
    v_cmp_ne_u32 vcc, v14, v52
    s_nop 4
    s_cbranch_vccz L_polld_21
    s_sleep 4
    s_cmp_lt_u32 s42, 0x40000
    s_cbranch_scc1 L_poll_20
L_polld_21:
L_hnf_19:
    s_waitcnt lgkmcnt(0)
    s_barrier
    s_barrier
    s_barrier
    ds_read_b128 v[24:27], v19 offset:15872
    ds_read_b128 v[28:31], v19 offset:15888
    ds_read_b128 v[32:35], v19 offset:16384
    ds_read_b128 v[36:39], v19 offset:16400
    s_lshl_b32 s44, s30, 4
    s_add_u32 s44, s44, 32768
    v_lshlrev_b32 v8, 1, v2
    v_add_u32 v8, v8, v3
    v_mul_u32_u24 v8, 3584, v8
    v_add_u32 v8, s44, v8
    v_mov_b32 v6, v52
    v_mov_b32 v7, v52
    s_waitcnt lgkmcnt(0)
    v_max3_f32 v4, v24, v25, v26
    v_max3_f32 v5, v27, v28, v29
    v_max3_f32 v4, v4, v30, v31
    v_max_f32 v4, v4, v5
    v_ceil_f32 v4, v4
    v_add_f32 v32, v32, v33
    v_add_f32 v34, v34, v35
    v_add_f32 v36, v36, v37
    v_add_f32 v38, v38, v39
    v_add_f32 v32, v32, v34
    v_add_f32 v36, v36, v38
    v_add_f32 v5, v32, v36
    s_mov_b32 exec_lo, -1
    s_mov_b32 exec_hi, 0
    global_store_dwordx4 v8, v[4:7], s[26:27] sc1
    s_mov_b64 exec, -1
    s_nop 0
    s_cmp_lg_u32 s54, 0
    s_cbranch_scc1 L_fin_tail
    s_branch L_end
L_fin_tail:
    s_lshr_b32 s46, s53, 1
    v_mov_b32 v4, 17408
    ds_read_b32 v10, v4
    s_waitcnt lgkmcnt(0)
    s_mul_i32 s33, s28, 28
    v_min_u32 v4, 27, v1
    v_add_u32 v4, s33, v4
    v_lshlrev_b32 v4, 4, v4
    s_mul_i32 s34, s53, 3584
    s_add_u32 s34, s34, 32768
    v_add_u32 v4, s34, v4
    s_mul_i32 s34, s53, 224
    s_add_u32 s34, s34, s33
    s_mul_i32 s34, s34, 192
    s_add_u32 s34, s34, 163840
    v_min_u32 v5, 47, v1
    v_lshlrev_b32 v5, 4, v5
    v_add_u32 v5, s34, v5
    v_add_u32 v6, 3840, v5
    s_mov_b32 s42, 0
    s_nop 1
L_poll_22:
    s_cmp_lg_u32 s58, 0
    s_cbranch_scc1 L_nd_24
    global_load_dwordx4 v[200:203], v4, s[26:27] sc1
L_nd_24:
    s_add_u32 s42, s42, 1
    s_waitcnt vmcnt(0)
    v_cmp_ne_u32 vcc, v202, v10
    s_nop 4
    s_cbranch_vccz L_polld_23
    s_cmp_lt_u32 s42, 0x40000
    s_cbranch_scc1 L_poll_22
L_polld_23:
    s_cmp_lg_u32 s58, 0
    s_cbranch_scc1 L_nd_25
    global_load_dwordx4 v[24:27], v5, s[26:27] offset:0 sc1
    global_load_dwordx4 v[28:31], v5, s[26:27] offset:768 sc1
    global_load_dwordx4 v[32:35], v5, s[26:27] offset:1536 sc1
    global_load_dwordx4 v[36:39], v5, s[26:27] offset:2304 sc1
    global_load_dwordx4 v[40:43], v5, s[26:27] offset:3072 sc1
    global_load_dwordx4 v[44:47], v6, s[26:27] offset:0 sc1
    global_load_dwordx4 v[48:51], v6, s[26:27] offset:768 sc1
L_nd_25:
    v_mov_b32 v202, v200
    s_nop 1
    v_max_f32_dpp v202, v202, v202 row_ror:1 row_mask:0xf bank_mask:0xf
    s_nop 1
    v_max_f32_dpp v202, v202, v202 row_ror:2 row_mask:0xf bank_mask:0xf
    s_nop 1
    v_max_f32_dpp v202, v202, v202 row_ror:4 row_mask:0xf bank_mask:0xf
    s_nop 1
    v_max_f32_dpp v202, v202, v202 row_ror:8 row_mask:0xf bank_mask:0xf
    v_mov_b32 v203, v202
    s_nop 1
    v_permlane16_swap_b32 v202, v203
    v_max_f32 v202, v202, v203
    v_mov_b32 v203, v202
    s_nop 1
    v_permlane32_swap_b32 v202, v203
    v_max_f32 v202, v202, v203
    s_lshl_b32 s35, s28, 2
    v_mov_b32 v8, s35
    ds_write_b32 v8, v202 offset:25344
    v_sub_f32 v200, v200, v202
    v_exp_f32 v200, v200
    v_cmp_gt_u32 vcc, 28, v1
    v_mul_f32 v201, v201, v200
    s_nop 0
    v_cndmask_b32 v201, 0, v201, vcc
    v_lshrrev_b32 v200, 16, v200
    s_lshl_b32 s34, s28, 7
    s_add_u32 s34, s34, 24320
    v_lshl_add_u32 v9, v1, 2, s34
    s_mov_b32 exec_hi, 0
    ds_write_b32 v9, v200
    s_mov_b32 exec_hi, s57
    v_mul_u32_u24 v9, 43, v1
    v_lshrrev_b32 v9, 9, v9
    v_min_u32 v9, 3, v9
    v_lshl_add_u32 v9, v9, 2, s34
    v_add_f32_dpp v201, v201, v201 row_ror:1 row_mask:0xf bank_mask:0xf
    s_nop 1
    v_add_f32_dpp v201, v201, v201 row_ror:2 row_mask:0xf bank_mask:0xf
    s_nop 1
    v_add_f32_dpp v201, v201, v201 row_ror:4 row_mask:0xf bank_mask:0xf
    s_nop 1
    v_add_f32_dpp v201, v201, v201 row_ror:8 row_mask:0xf bank_mask:0xf
    v_mov_b32 v203, v201
    s_nop 1
    v_permlane16_swap_b32 v201, v203
    v_add_f32 v201, v201, v203
    s_waitcnt lgkmcnt(0)
    ds_read_b32 v204, v9 offset:0
    ds_read_b32 v205, v9 offset:16
    ds_read_b32 v206, v9 offset:32
    ds_read_b32 v207, v9 offset:48
    ds_read_b32 v208, v9 offset:64
    ds_read_b32 v209, v9 offset:80
    ds_read_b32 v210, v9 offset:96
    s_and_b32 exec_lo, s56, 1
    s_mov_b32 exec_hi, 0
    ds_write_b32 v8, v201 offset:25376
    s_mov_b64 exec, s[56:57]
L_redo_26:
    v_mov_b32 v188, 0
    v_mov_b32 v189, 0
    v_mov_b32 v190, 0
    v_mov_b32 v191, 0
    v_mov_b32 v192, 0
    v_mov_b32 v193, 0
    v_mov_b32 v194, 0
    v_mov_b32 v195, 0
    v_mov_b32 v214, 0
    s_waitcnt lgkmcnt(0)
    v_lshlrev_b32 v212, 16, v204
    s_waitcnt vmcnt(6)
    v_max3_u32 v214, v214, v24, v25
    v_max3_u32 v214, v214, v26, v27
    v_dot2c_f32_bf16 v188, v24, v204
    v_dot2c_f32_bf16 v189, v24, v212
    v_dot2c_f32_bf16 v190, v25, v204
    v_dot2c_f32_bf16 v191, v25, v212
    v_dot2c_f32_bf16 v192, v26, v204
    v_dot2c_f32_bf16 v193, v26, v212
    v_dot2c_f32_bf16 v194, v27, v204
    v_dot2c_f32_bf16 v195, v27, v212
    v_lshlrev_b32 v213, 16, v205
    s_waitcnt vmcnt(5)
    v_max3_u32 v214, v214, v28, v29
    v_max3_u32 v214, v214, v30, v31
    v_dot2c_f32_bf16 v188, v28, v205
    v_dot2c_f32_bf16 v189, v28, v213
    v_dot2c_f32_bf16 v190, v29, v205
    v_dot2c_f32_bf16 v191, v29, v213
    v_dot2c_f32_bf16 v192, v30, v205
    v_dot2c_f32_bf16 v193, v30, v213
    v_dot2c_f32_bf16 v194, v31, v205
    v_dot2c_f32_bf16 v195, v31, v213
    v_lshlrev_b32 v212, 16, v206
    s_waitcnt vmcnt(4)
    v_max3_u32 v214, v214, v32, v33
    v_max3_u32 v214, v214, v34, v35
    v_dot2c_f32_bf16 v188, v32, v206
    v_dot2c_f32_bf16 v189, v32, v212
    v_dot2c_f32_bf16 v190, v33, v206
    v_dot2c_f32_bf16 v191, v33, v212
    v_dot2c_f32_bf16 v192, v34, v206
    v_dot2c_f32_bf16 v193, v34, v212
    v_dot2c_f32_bf16 v194, v35, v206
    v_dot2c_f32_bf16 v195, v35, v212
    v_lshlrev_b32 v213, 16, v207
    s_waitcnt vmcnt(3)
    v_max3_u32 v214, v214, v36, v37
    v_max3_u32 v214, v214, v38, v39
    v_dot2c_f32_bf16 v188, v36, v207
    v_dot2c_f32_bf16 v189, v36, v213
    v_dot2c_f32_bf16 v190, v37, v207
    v_dot2c_f32_bf16 v191, v37, v213
    v_dot2c_f32_bf16 v192, v38, v207
    v_dot2c_f32_bf16 v193, v38, v213
    v_dot2c_f32_bf16 v194, v39, v207
    v_dot2c_f32_bf16 v195, v39, v213
    v_lshlrev_b32 v212, 16, v208
    s_waitcnt vmcnt(2)
    v_max3_u32 v214, v214, v40, v41
    v_max3_u32 v214, v214, v42, v43
    v_dot2c_f32_bf16 v188, v40, v208
    v_dot2c_f32_bf16 v189, v40, v212
    v_dot2c_f32_bf16 v190, v41, v208
    v_dot2c_f32_bf16 v191, v41, v212
    v_dot2c_f32_bf16 v192, v42, v208
    v_dot2c_f32_bf16 v193, v42, v212
    v_dot2c_f32_bf16 v194, v43, v208
    v_dot2c_f32_bf16 v195, v43, v212
    v_lshlrev_b32 v213, 16, v209
    s_waitcnt vmcnt(1)
    v_max3_u32 v214, v214, v44, v45
    v_max3_u32 v214, v214, v46, v47
    v_dot2c_f32_bf16 v188, v44, v209
    v_dot2c_f32_bf16 v189, v44, v213
    v_dot2c_f32_bf16 v190, v45, v209
    v_dot2c_f32_bf16 v191, v45, v213
    v_dot2c_f32_bf16 v192, v46, v209
    v_dot2c_f32_bf16 v193, v46, v213
    v_dot2c_f32_bf16 v194, v47, v209
    v_dot2c_f32_bf16 v195, v47, v213
    v_lshlrev_b32 v212, 16, v210
    s_waitcnt vmcnt(0)
    v_max3_u32 v214, v214, v48, v49
    v_max3_u32 v214, v214, v50, v51
    v_dot2c_f32_bf16 v188, v48, v210
    v_dot2c_f32_bf16 v189, v48, v212
    v_dot2c_f32_bf16 v190, v49, v210
    v_dot2c_f32_bf16 v191, v49, v212
    v_dot2c_f32_bf16 v192, v50, v210
    v_dot2c_f32_bf16 v193, v50, v212
    v_dot2c_f32_bf16 v194, v51, v210
    v_dot2c_f32_bf16 v195, v51, v212
    v_cmp_eq_u32 vcc, -1, v214
    s_nop 4
    s_cbranch_vccz L_zok_27
    s_add_u32 s42, s42, 1
    s_cmp_ge_u32 s42, 0x40000
    s_cbranch_scc1 L_zok_27
    s_cmp_lg_u32 s58, 0
    s_cbranch_scc1 L_nd_28
    global_load_dwordx4 v[24:27], v5, s[26:27] offset:0 sc1
    global_load_dwordx4 v[28:31], v5, s[26:27] offset:768 sc1
    global_load_dwordx4 v[32:35], v5, s[26:27] offset:1536 sc1
    global_load_dwordx4 v[36:39], v5, s[26:27] offset:2304 sc1
    global_load_dwordx4 v[40:43], v5, s[26:27] offset:3072 sc1
    global_load_dwordx4 v[44:47], v6, s[26:27] offset:0 sc1
    global_load_dwordx4 v[48:51], v6, s[26:27] offset:768 sc1
L_nd_28:
    s_branch L_redo_26
L_zok_27:
    v_cvt_pk_bf16_f32 v204, v188, v189
    v_cvt_pk_bf16_f32 v205, v190, v191
    v_cvt_pk_bf16_f32 v206, v192, v193
    v_cvt_pk_bf16_f32 v207, v194, v195
    v_mul_u32_u24 v8, 43, v1
    v_lshrrev_b32 v8, 9, v8
    v_mul_u32_u24 v9, 12, v8
    v_sub_u32 v9, v1, v9
    s_lshl_b32 s34, s28, 2
    v_add_u32 v8, s34, v8
    v_mul_u32_u24 v8, 208, v8
    v_lshrrev_b32 v10, 2, v9
    v_lshl_add_u32 v8, v10, 6, v8
    v_and_b32 v10, 1, v9
    v_lshl_add_u32 v8, v10, 5, v8
    v_bfe_u32 v10, v9, 1, 1
    v_lshl_add_u32 v8, v10, 3, v8
    s_and_b32 exec_hi, s57, 0xffff
    ds_write_b64 v8, v[204:205] offset:17664
    ds_write_b64 v8, v[206:207] offset:17680
    s_mov_b32 exec_hi, s57
    s_waitcnt lgkmcnt(0)
    s_cmp_lg_u32 s58, 0
    s_cbranch_scc1 L_bar_29
    s_barrier
L_bar_29:
    s_cmp_ge_u32 s28, 6
    s_cbranch_scc1 L_end
    v_mul_u32_u24 v6, 208, v2
    v_lshl_add_u32 v6, v3, 4, v6
    v_mov_b32 v7, 0
    v_lshlrev_b32 v9, 2, v3
    ds_read_b128 v[24:27], v6 offset:17664
    ds_read_b128 v[28:31], v6 offset:17728
    ds_read_b128 v[32:35], v6 offset:17792
    ds_read_b128 v[36:39], v6 offset:20992
    ds_read_b128 v[40:43], v6 offset:21056
    ds_read_b128 v[44:47], v6 offset:21120
    ds_read_b128 v[48:51], v7 offset:25376
    ds_read_b128 v[52:55], v7 offset:25392
    ds_read_b128 v[96:99], v7 offset:25344
    ds_read_b128 v[100:103], v7 offset:25360
    ds_read_b32 v104, v9 offset:25344
    ds_read_b32 v105, v9 offset:25360
    s_waitcnt lgkmcnt(11)
    v_mfma_f32_16x16x32_bf16 v[108:111], v[24:27], v[148:151], 0
    v_mfma_f32_16x16x32_bf16 v[112:115], v[24:27], v[160:163], 0
    s_waitcnt lgkmcnt(10)
    v_mfma_f32_16x16x32_bf16 v[108:111], v[28:31], v[152:155], v[108:111]
    v_mfma_f32_16x16x32_bf16 v[112:115], v[28:31], v[164:167], v[112:115]
    s_waitcnt lgkmcnt(9)
    v_mfma_f32_16x16x32_bf16 v[108:111], v[32:35], v[156:159], v[108:111]
    v_mfma_f32_16x16x32_bf16 v[112:115], v[32:35], v[168:171], v[112:115]
    s_waitcnt lgkmcnt(8)
    v_mfma_f32_16x16x32_bf16 v[116:119], v[36:39], v[148:151], 0
    v_mfma_f32_16x16x32_bf16 v[120:123], v[36:39], v[160:163], 0
    s_waitcnt lgkmcnt(7)
    v_mfma_f32_16x16x32_bf16 v[116:119], v[40:43], v[152:155], v[116:119]
    v_mfma_f32_16x16x32_bf16 v[120:123], v[40:43], v[164:167], v[120:123]
    s_waitcnt lgkmcnt(6)
    v_mfma_f32_16x16x32_bf16 v[116:119], v[44:47], v[156:159], v[116:119]
    v_mfma_f32_16x16x32_bf16 v[120:123], v[44:47], v[168:171], v[120:123]
    s_waitcnt lgkmcnt(0)
    v_max3_f32 v200, v96, v97, v98
    v_max3_f32 v201, v99, v100, v101
    v_max3_f32 v200, v200, v102, v103
    v_max_f32 v200, v200, v201
    v_sub_f32 v96, v96, v200
    v_sub_f32 v97, v97, v200
    v_sub_f32 v98, v98, v200
    v_sub_f32 v99, v99, v200
    v_sub_f32 v100, v100, v200
    v_sub_f32 v101, v101, v200
    v_sub_f32 v102, v102, v200
    v_sub_f32 v103, v103, v200
    v_sub_f32 v104, v104, v200
    v_sub_f32 v105, v105, v200
    v_exp_f32 v96, v96
    v_exp_f32 v97, v97
    v_exp_f32 v98, v98
    v_exp_f32 v99, v99
    v_exp_f32 v100, v100
    v_exp_f32 v101, v101
    v_exp_f32 v102, v102
    v_exp_f32 v103, v103
    v_exp_f32 v104, v104
    v_exp_f32 v105, v105
    v_mul_f32 v201, v48, v96
    v_fmac_f32 v201, v49, v97
    v_fmac_f32 v201, v50, v98
    v_fmac_f32 v201, v51, v99
    v_fmac_f32 v201, v52, v100
    v_fmac_f32 v201, v53, v101
    v_fmac_f32 v201, v54, v102
    v_fmac_f32 v201, v55, v103
    v_rcp_f32 v201, v201
    s_nop 0
    v_mul_f32 v104, v104, v201
    v_mul_f32 v105, v105, v201
    v_add_f32 v108, v108, v109
    v_add_f32 v110, v110, v111
    v_add_f32 v116, v116, v117
    v_add_f32 v118, v118, v119
    v_add_f32 v112, v112, v113
    v_add_f32 v114, v114, v115
    v_add_f32 v120, v120, v121
    v_add_f32 v122, v122, v123
    v_add_f32 v108, v108, v110
    v_add_f32 v116, v116, v118
    v_add_f32 v112, v112, v114
    v_add_f32 v120, v120, v122
    v_mul_f32 v204, v108, v104
    v_fmac_f32 v204, v116, v105
    v_mul_f32 v205, v112, v104
    v_fmac_f32 v205, v120, v105
    v_mov_b32 v206, v204
    v_mov_b32 v207, v205
    s_nop 0
    v_permlane16_swap_b32 v204, v206
    v_permlane16_swap_b32 v205, v207
    v_add_f32 v204, v204, v206
    v_add_f32 v205, v205, v207
    v_mov_b32 v206, v204
    v_mov_b32 v207, v205
    s_nop 0
    v_permlane32_swap_b32 v204, v206
    v_permlane32_swap_b32 v205, v207
    v_add_f32 v204, v204, v206
    v_add_f32 v205, v205, v207
    s_nop 0
    v_mov_b32_dpp v206, v204 quad_perm:[1,1,3,3] row_mask:0xf bank_mask:0xf
    v_mov_b32_dpp v207, v205 quad_perm:[1,1,3,3] row_mask:0xf bank_mask:0xf
    v_cvt_pk_bf16_f32 v208, v204, v206
    v_cvt_pk_bf16_f32 v209, v205, v207
    s_mul_i32 s33, s46, 384
    s_lshl_b32 s34, s28, 6
    s_add_u32 s33, s33, s34
    v_lshl_add_u32 v4, v2, 1, s33
    s_and_b32 exec_lo, s56, 0x5555
    s_mov_b32 exec_hi, 0
    s_nop 0
    s_cmp_lg_u32 s58, 0
    s_cbranch_scc1 L_nd_30
    global_atomic_pk_add_bf16 v4, v208, s[22:23]
    global_atomic_pk_add_bf16 v4, v209, s[22:23] offset:32
L_nd_30:
    s_cmp_lg_u32 s58, 0
    s_cbranch_scc1 L_fin_dry_ret
    s_branch L_end
L_helpers:
    s_lshr_b32 s30, s2, 3
    s_cmp_ge_u32 s30, 24
    s_cbranch_scc1 L_end
    s_cmp_ge_u32 s30, 12
    s_cbranch_scc1 L_role_wvo
    s_cmp_ge_u32 s28, 4
    s_cbranch_scc1 L_qk_warm_31
    s_mul_i32 s32, s30, 86
    s_lshr_b32 s32, s32, 8
    s_mul_i32 s31, s32, 3
    s_sub_u32 s31, s30, s31
    v_lshrrev_b32 v5, 3, v1
    v_mul_u32_u24 v5, 384, v5
    v_and_b32 v6, 7, v1
    v_bfe_u32 v7, v1, 4, 1
    v_lshlrev_b32 v7, 1, v7
    v_xor_b32 v6, v6, v7
    s_lshl_b32 s33, s31, 7
    s_mul_i32 s34, s28, 18432
    s_add_u32 s34, s34, s33
    v_add_u32 v8, s34, v5
    v_lshl_add_u32 v9, v6, 4, v8
    v_xor_b32 v6, 4, v6
    v_lshl_add_u32 v10, v6, 4, v8
    v_add_u32 v10, 3072, v10
    s_mul_i32 s34, s28, 6144
    s_add_u32 m0, s34, 24832
    s_nop 0
    global_load_lds_dwordx4 v9, s[14:15]
    v_add_u32 v9, 6144, v9
    s_add_u32 m0, m0, 1024
    s_nop 0
    global_load_lds_dwordx4 v10, s[14:15]
    v_add_u32 v10, 6144, v10
    s_add_u32 m0, m0, 1024
    s_nop 0
    global_load_lds_dwordx4 v9, s[14:15]
    v_add_u32 v9, 6144, v9
    s_add_u32 m0, m0, 1024
    s_nop 0
    global_load_lds_dwordx4 v10, s[14:15]
    v_add_u32 v10, 6144, v10
    s_add_u32 m0, m0, 1024
    s_nop 0
    global_load_lds_dwordx4 v9, s[14:15]
    s_add_u32 m0, m0, 1024
    s_nop 0
    global_load_lds_dwordx4 v10, s[14:15]
    s_cmp_ge_u32 s28, 3
    s_cbranch_scc1 L_qk_noq_33
    s_lshl_b32 s33, s28, 7
    s_movk_i32 s34, 2731
    v_add_u32 v6, s33, v1
    v_add_u32 v6, 0, v6
    v_mul_u32_u24 v7, s34, v6
    v_lshrrev_b32 v7, 16, v7
    v_mul_u32_u24 v8, 24, v7
    v_sub_u32 v6, v6, v8
    v_bfe_u32 v8, v7, 1, 3
    v_xor_b32 v6, v6, v8
    v_mul_u32_u24 v7, 384, v7
    v_lshl_add_u32 v6, v6, 4, v7
    s_lshl_b32 s35, s28, 11
    s_add_u32 m0, s35, 12544
    s_nop 0
    global_load_lds_dwordx4 v6, s[8:9]
    v_add_u32 v6, s33, v1
    v_add_u32 v6, 64, v6
    v_mul_u32_u24 v7, s34, v6
    v_lshrrev_b32 v7, 16, v7
    v_mul_u32_u24 v8, 24, v7
    v_sub_u32 v6, v6, v8
    v_bfe_u32 v8, v7, 1, 3
    v_xor_b32 v6, v6, v8
    v_mul_u32_u24 v7, 384, v7
    v_lshl_add_u32 v6, v6, 4, v7
    s_lshl_b32 s35, s28, 11
    s_add_u32 m0, s35, 13568
    s_nop 0
    global_load_lds_dwordx4 v6, s[8:9]
    s_mul_i32 s33, s32, 48
    s_lshl_b32 s34, s28, 4
    s_add_u32 s33, s33, s34
    s_mul_i32 s33, s33, 384
    s_lshl_b32 s34, s31, 7
    s_add_u32 s33, s33, s34
    v_and_b32 v6, 7, v1
    v_lshl_add_u32 v6, v6, 4, v5
    v_add_u32 v6, s33, v6
    s_add_u32 m0, s35, 18688
    v_add_u32 v7, 3072, v6
    global_load_lds_dwordx4 v6, s[16:17]
    s_add_u32 m0, s35, 19712
    s_nop 0
    global_load_lds_dwordx4 v7, s[16:17]
L_qk_noq_33:
    v_mov_b32 v88, 0x3f803f80
    v_mov_b32 v89, 0x3f803f80
    v_mov_b32 v90, 0x3f803f80
    v_mov_b32 v91, 0x3f803f80
    v_mov_b32 v92, 1.0
    v_mov_b32 v93, 0
    v_mov_b32 v94, 0
    v_bfe_u32 v6, v2, 1, 3
    v_xor_b32 v6, v6, v3
    v_mul_u32_u24 v7, 384, v2
    v_lshl_add_u32 v151, v6, 4, v7
    v_xor_b32 v6, 4, v6
    v_lshl_add_u32 v152, v6, 4, v7
    v_lshlrev_b32 v4, 4, v1
    s_waitcnt vmcnt(0)
    s_nop 1
    s_branch L_qk_w8_32
L_qk_warm_31:
    s_cmp_lg_u32 s28, 7
    s_cbranch_scc1 L_qk7_34
    s_memrealtime s[40:41]
    s_lshl_b32 s33, s30, 2
    v_mov_b32 v6, s33
    v_mov_b32 v7, 12288
    s_waitcnt lgkmcnt(0)
    s_or_b32 s40, s40, 1
    v_mov_b32 v5, s40
    s_mov_b64 exec, 1
    global_store_dword v6, v5, s[24:25] sc1
    ds_write_b32 v7, v5
    s_mov_b64 exec, -1
L_qk7_34:
    s_cmp_lg_u32 s28, 4
    s_cbranch_scc1 L_qd_35
    s_mov_b32 s59, s28
    s_mov_b32 s28, 0
    s_mov_b32 s58, 1
    s_mov_b64 s[56:57], 0
    s_mov_b64 exec, 0
    s_branch L_qk_segA
L_qk_retA1:
    s_mov_b32 s28, s59
    s_mov_b32 s58, 0
    s_mov_b64 s[56:57], -1
    s_mov_b64 exec, -1
    s_branch L_qd_39
L_qd_35:
    s_cmp_lg_u32 s28, 5
    s_cbranch_scc1 L_qd_36
    s_mov_b32 s59, s28
    s_mov_b32 s28, 0
    s_mov_b32 s58, 2
    s_mov_b64 s[56:57], 0
    s_mov_b64 exec, 0
    s_branch L_qk_segA2
L_qk_retA:
    s_mov_b32 s28, s59
    s_mov_b32 s58, 0
    s_mov_b64 s[56:57], -1
    s_mov_b64 exec, -1
    s_branch L_qd_39
L_qd_36:
    s_cmp_lg_u32 s28, 6
    s_cbranch_scc1 L_qd_37
    s_mov_b32 s59, s28
    s_mov_b32 s28, 0
    s_mov_b32 s58, 1
    s_mov_b64 s[56:57], 0
    s_mov_b64 exec, 0
    s_branch L_qk_segB
L_qk_retB1:
    s_mov_b32 s28, s59
    s_mov_b32 s58, 0
    s_mov_b64 s[56:57], -1
    s_mov_b64 exec, -1
    s_branch L_qd_39
L_qd_37:
    s_mov_b32 s59, s28
    s_mov_b32 s28, 0
    s_mov_b32 s58, 2
    s_mov_b64 s[56:57], 0
    s_mov_b64 exec, 0
    s_branch L_qk_segB2
L_qk_retB:
    s_mov_b32 s28, s59
    s_mov_b32 s58, 0
    s_mov_b64 s[56:57], -1
    s_mov_b64 exec, -1
L_qd_39:
    s_waitcnt lgkmcnt(0)
L_qk_w8_32:
    s_barrier
    s_cmp_ge_u32 s28, 4
    s_cbranch_scc1 L_qk_wo_41
L_qk_segA:
    ds_read_b128 v[8:11], v151 offset:12544
    ds_read_b128 v[12:15], v152 offset:12544
    ds_read_b128 v[16:19], v151 offset:12672
    ds_read_b128 v[20:23], v152 offset:12672
    ds_read_b128 v[24:27], v151 offset:12800
    ds_read_b128 v[28:31], v152 offset:12800
    v_bfe_u32 v5, v1, 2, 2
    v_lshl_add_u32 v6, v3, 3, v5
    v_lshlrev_b32 v6, 7, v6
    v_lshrrev_b32 v5, 1, v5
    v_and_b32 v7, 1, v3
    v_lshl_or_b32 v5, v7, 1, v5
    v_lshlrev_b32 v5, 1, v5
    v_bfe_u32 v7, v1, 1, 1
    s_lshl_b32 s33, s28, 1
    v_or_b32 v7, s33, v7
    v_xor_b32 v5, v5, v7
    v_lshl_add_u32 v6, v5, 4, v6
    v_and_b32 v7, 1, v1
    v_lshl_add_u32 v6, v7, 3, v6
    ds_read_b64_tr_b16 v[40:41], v6 offset:24832
    ds_read_b64_tr_b16 v[42:43], v6 offset:25344
    ds_read_b64_tr_b16 v[44:45], v6 offset:28928
    ds_read_b64_tr_b16 v[46:47], v6 offset:29440
    ds_read_b64_tr_b16 v[48:49], v6 offset:33024
    ds_read_b64_tr_b16 v[50:51], v6 offset:33536
    ds_read_b64_tr_b16 v[52:53], v6 offset:37120
    ds_read_b64_tr_b16 v[54:55], v6 offset:37632
    ds_read_b64_tr_b16 v[56:57], v6 offset:41216
    ds_read_b64_tr_b16 v[58:59], v6 offset:41728
    ds_read_b64_tr_b16 v[60:61], v6 offset:45312
    ds_read_b64_tr_b16 v[62:63], v6 offset:45824
    v_lshlrev_b32 v7, 7, v2
    v_lshl_add_u32 v7, v3, 3, v7
    s_lshl_b32 s33, s28, 5
    v_add_u32 v7, s33, v7
    ds_read_b64 v[32:33], v7 offset:18688
    ds_read_b64 v[34:35], v7 offset:20736
    ds_read_b64 v[36:37], v7 offset:22784
    s_waitcnt lgkmcnt(15)
    v_mfma_f32_16x16x32_bf16 v[96:99], v[88:91], v[8:11], 0
    s_waitcnt lgkmcnt(15)
    v_mfma_f32_16x16x32_bf16 v[96:99], v[88:91], v[12:15], v[96:99]
    s_waitcnt lgkmcnt(15)
    v_mfma_f32_16x16x32_bf16 v[96:99], v[88:91], v[16:19], v[96:99]
    s_waitcnt lgkmcnt(15)
    v_mfma_f32_16x16x32_bf16 v[96:99], v[88:91], v[20:23], v[96:99]
    s_waitcnt lgkmcnt(15)
    v_mfma_f32_16x16x32_bf16 v[96:99], v[88:91], v[24:27], v[96:99]
    s_waitcnt lgkmcnt(15)
    v_mfma_f32_16x16x32_bf16 v[96:99], v[88:91], v[28:31], v[96:99]
    v_dot2c_f32_bf16 v93, v8, v8
    v_dot2c_f32_bf16 v94, v9, v9
    v_dot2c_f32_bf16 v93, v10, v10
    v_dot2c_f32_bf16 v94, v11, v11
    v_dot2c_f32_bf16 v93, v12, v12
    v_dot2c_f32_bf16 v94, v13, v13
    v_dot2c_f32_bf16 v93, v14, v14
    v_dot2c_f32_bf16 v94, v15, v15
    v_dot2c_f32_bf16 v93, v16, v16
    v_dot2c_f32_bf16 v94, v17, v17
    v_dot2c_f32_bf16 v93, v18, v18
    v_dot2c_f32_bf16 v94, v19, v19
    v_dot2c_f32_bf16 v93, v20, v20
    v_dot2c_f32_bf16 v94, v21, v21
    v_dot2c_f32_bf16 v93, v22, v22
    v_dot2c_f32_bf16 v94, v23, v23
    v_dot2c_f32_bf16 v93, v24, v24
    v_dot2c_f32_bf16 v94, v25, v25
    v_dot2c_f32_bf16 v93, v26, v26
    v_dot2c_f32_bf16 v94, v27, v27
    v_dot2c_f32_bf16 v93, v28, v28
    v_dot2c_f32_bf16 v94, v29, v29
    v_dot2c_f32_bf16 v93, v30, v30
    v_dot2c_f32_bf16 v94, v31, v31
    s_nop 2
    v_add_f32 v93, v93, v94
    s_nop 1
    v_mfma_f32_16x16x4_f32 v[100:103], v92, v93, 0
    s_nop 11
    s_cmp_eq_u32 s58, 1
    s_cbranch_scc1 L_qk_retA1
L_qk_segA2:
    s_waitcnt lgkmcnt(13)
    v_mfma_f32_16x16x32_bf16 v[124:127], v[40:43], v[8:11], 0
    v_mfma_f32_16x16x32_bf16 v[104:107], v[40:43], v[88:91], 0
    s_waitcnt lgkmcnt(11)
    v_mfma_f32_16x16x32_bf16 v[124:127], v[44:47], v[12:15], v[124:127]
    v_mfma_f32_16x16x32_bf16 v[104:107], v[44:47], v[88:91], v[104:107]
    s_waitcnt lgkmcnt(9)
    v_mfma_f32_16x16x32_bf16 v[124:127], v[48:51], v[16:19], v[124:127]
    v_mfma_f32_16x16x32_bf16 v[104:107], v[48:51], v[88:91], v[104:107]
    s_waitcnt lgkmcnt(7)
    v_mfma_f32_16x16x32_bf16 v[124:127], v[52:55], v[20:23], v[124:127]
    v_mfma_f32_16x16x32_bf16 v[104:107], v[52:55], v[88:91], v[104:107]
    s_waitcnt lgkmcnt(5)
    v_mfma_f32_16x16x32_bf16 v[124:127], v[56:59], v[24:27], v[124:127]
    v_mfma_f32_16x16x32_bf16 v[104:107], v[56:59], v[88:91], v[104:107]
    s_waitcnt lgkmcnt(3)
    v_mfma_f32_16x16x32_bf16 v[124:127], v[60:63], v[28:31], v[124:127]
    v_mfma_f32_16x16x32_bf16 v[104:107], v[60:63], v[88:91], v[104:107]
    s_mov_b32 s36, 0x3baaaaab
    v_mul_f32 v96, s36, v96
    v_mul_f32 v100, s36, v100
    v_fma_f32 v100, -v96, v96, v100
    v_max_f32 v100, 0, v100
    v_add_f32 v100, 0x3727c5ac, v100
    v_rsq_f32 v100, v100
    s_nop 0
    v_fma_f32 v124, -v96, v104, v124
    v_fma_f32 v125, -v96, v105, v125
    v_fma_f32 v126, -v96, v106, v126
    v_fma_f32 v127, -v96, v107, v127
    v_mul_f32 v124, v124, v100
    v_mul_f32 v125, v125, v100
    v_mul_f32 v126, v126, v100
    v_mul_f32 v127, v127, v100
    v_cvt_pk_bf16_f32 v128, v124, v125
    v_cvt_pk_bf16_f32 v129, v126, v127
    s_waitcnt lgkmcnt(0)
    s_nop 0
    v_mfma_f32_16x16x16_bf16 v[132:135], v[32:33], v[128:129], 0
    v_mfma_f32_16x16x16_bf16 v[136:139], v[34:35], v[128:129], 0
    v_mfma_f32_16x16x16_bf16 v[140:143], v[36:37], v[128:129], 0
    s_mul_i32 s33, s28, 3072
    v_add_u32 v5, s33, v4
    s_nop 3
    ds_write_b128 v5, v[132:135] offset:0
    ds_write_b128 v5, v[136:139] offset:1024
    ds_write_b128 v5, v[140:143] offset:2048
    s_waitcnt lgkmcnt(0)
    s_cmp_lg_u32 s58, 0
    s_cbranch_scc1 L_qk_retA
L_qk_wo_41:
L_qk_b3_40:
    s_barrier
    s_cmp_ge_u32 s28, 2
    s_cbranch_scc1 L_qk_done_42
L_qk_segB:
    v_lshrrev_b32 v5, 3, v1
    s_lshl_b32 s33, s28, 3
    v_add_u32 v5, s33, v5
    v_lshlrev_b32 v5, 4, v5
    v_and_b32 v6, 7, v1
    v_mul_u32_u24 v6, 6, v6
    v_mov_b32 v10, 12288
    ds_read_b32 v35, v10
    v_add_u32 v7, 0, v6
    v_lshrrev_b32 v8, 2, v7
    v_lshl_add_u32 v8, v8, 8, v5
    v_and_b32 v7, 3, v7
    v_lshl_add_u32 v150, v7, 2, v8
    v_add_u32 v7, 2, v6
    v_lshrrev_b32 v8, 2, v7
    v_lshl_add_u32 v8, v8, 8, v5
    v_and_b32 v7, 3, v7
    v_lshl_add_u32 v151, v7, 2, v8
    v_add_u32 v7, 4, v6
    v_lshrrev_b32 v8, 2, v7
    v_lshl_add_u32 v8, v8, 8, v5
    v_and_b32 v7, 3, v7
    v_lshl_add_u32 v152, v7, 2, v8
    ds_read_b64 v[40:41], v150 offset:0
    ds_read_b64 v[42:43], v150 offset:3072
    ds_read_b64 v[44:45], v150 offset:6144
    ds_read_b64 v[46:47], v150 offset:9216
    ds_read_b64 v[48:49], v151 offset:0
    ds_read_b64 v[50:51], v151 offset:3072
    ds_read_b64 v[52:53], v151 offset:6144
    ds_read_b64 v[54:55], v151 offset:9216
    ds_read_b64 v[56:57], v152 offset:0
    ds_read_b64 v[58:59], v152 offset:3072
    ds_read_b64 v[60:61], v152 offset:6144
    ds_read_b64 v[62:63], v152 offset:9216
    s_cmp_eq_u32 s58, 1
    s_cbranch_scc1 L_qk_retB1
L_qk_segB2:
    s_mov_b32 s36, 0x3dd53b95
    s_mul_i32 s33, s31, 8192
    s_lshl_b32 s34, s32, 11
    s_add_u32 s33, s33, s34
    s_lshl_b32 s34, s28, 10
    s_add_u32 s33, s33, s34
    v_add_u32 v5, s33, v4
    s_waitcnt lgkmcnt(0)
    v_add_f32 v40, v40, v42
    v_add_f32 v44, v44, v46
    v_add_f32 v41, v41, v43
    v_add_f32 v45, v45, v47
    v_add_f32 v48, v48, v50
    v_add_f32 v52, v52, v54
    v_add_f32 v49, v49, v51
    v_add_f32 v53, v53, v55
    v_add_f32 v56, v56, v58
    v_add_f32 v60, v60, v62
    v_add_f32 v57, v57, v59
    v_add_f32 v61, v61, v63
    v_add_f32 v40, v40, v44
    v_add_f32 v41, v41, v45
    v_add_f32 v48, v48, v52
    v_add_f32 v49, v49, v53
    v_add_f32 v56, v56, v60
    v_add_f32 v57, v57, v61
    v_mul_f32 v40, s36, v40
    v_mul_f32 v41, s36, v41
    v_mul_f32 v48, s36, v48
    v_mul_f32 v49, s36, v49
    v_mul_f32 v56, s36, v56
    v_mul_f32 v57, s36, v57
    v_cvt_pk_bf16_f32 v32, v40, v41
    v_cvt_pk_bf16_f32 v33, v48, v49
    v_cvt_pk_bf16_f32 v34, v56, v57
    s_nop 2
    s_cmp_lg_u32 s58, 0
    s_cbranch_scc1 L_nd_43
    global_store_dwordx4 v5, v[32:35], s[26:27] offset:0 sc1
    s_nop 1
L_nd_43:
    s_cmp_lg_u32 s58, 0
    s_cbranch_scc1 L_qk_retB
L_qk_done_42:
    s_branch L_end
L_role_wvo:
    s_sub_u32 s30, s30, 12
    s_cmp_ge_u32 s30, 6
    s_cselect_b32 s31, 1, 0
    s_mul_i32 s32, s31, 6
    s_sub_u32 s32, s30, s32
    s_cmp_ge_u32 s28, 6
    s_cbranch_scc1 L_wvo_a_44
    s_mul_i32 s33, s28, 6144
    s_mul_i32 s34, s31, 36864
    s_add_u32 s34, s34, s33
    v_lshl_add_u32 v9, v1, 4, s34
    s_add_u32 s34, s33, 12544
    s_add_u32 m0, s34, 0
    s_nop 0
    global_load_lds_dwordx4 v9, s[18:19]
    s_add_u32 m0, s34, 1024
    v_add_u32 v9, 1024, v9
    global_load_lds_dwordx4 v9, s[18:19]
    s_add_u32 m0, s34, 2048
    v_add_u32 v9, 1024, v9
    global_load_lds_dwordx4 v9, s[18:19]
    s_add_u32 m0, s34, 3072
    v_add_u32 v9, 1024, v9
    global_load_lds_dwordx4 v9, s[18:19]
    s_add_u32 m0, s34, 4096
    v_add_u32 v9, 1024, v9
    global_load_lds_dwordx4 v9, s[18:19]
    s_add_u32 m0, s34, 5120
    v_add_u32 v9, 1024, v9
    global_load_lds_dwordx4 v9, s[18:19]
    s_nop 1
    s_branch L_wvo_b_45
L_wvo_a_44:
    s_sub_u32 s33, s28, 6
    v_lshrrev_b32 v9, 2, v1
    v_mul_u32_u24 v9, 384, v9
    v_and_b32 v8, 3, v1
    v_lshl_add_u32 v9, v8, 4, v9
    s_mul_i32 s34, s33, 36864
    s_lshl_b32 s35, s32, 6
    s_add_u32 s34, s34, s35
    v_add_u32 v9, s34, v9
    s_mul_i32 s34, s33, 6144
    s_add_u32 s34, s34, 49408
    s_add_u32 m0, s34, 0
    s_nop 0
    global_load_lds_dwordx4 v9, s[20:21]
    s_add_u32 m0, s34, 1024
    v_add_u32 v9, 6144, v9
    global_load_lds_dwordx4 v9, s[20:21]
    s_add_u32 m0, s34, 2048
    v_add_u32 v9, 6144, v9
    global_load_lds_dwordx4 v9, s[20:21]
    s_add_u32 m0, s34, 3072
    v_add_u32 v9, 6144, v9
    global_load_lds_dwordx4 v9, s[20:21]
    s_add_u32 m0, s34, 4096
    v_add_u32 v9, 6144, v9
    global_load_lds_dwordx4 v9, s[20:21]
    s_add_u32 m0, s34, 5120
    v_add_u32 v9, 6144, v9
    global_load_lds_dwordx4 v9, s[20:21]
    s_nop 1
L_wvo_b_45:
    s_waitcnt vmcnt(0)
    s_barrier
    s_cmp_ge_u32 s28, 6
    s_cbranch_scc1 L_wvo_d_46
    v_bfe_u32 v6, v1, 2, 2
    v_lshl_add_u32 v6, v3, 3, v6
    v_lshlrev_b32 v6, 6, v6
    v_and_b32 v7, 3, v1
    v_lshl_add_u32 v6, v7, 3, v6
    v_mul_u32_u24 v7, 384, v2
    v_lshl_add_u32 v7, v3, 4, v7
    s_mul_i32 s33, s28, 6144
    s_add_u32 s33, s33, 12544
    v_add_u32 v7, s33, v7
    ds_read_b128 v[72:75], v7 offset:0
    ds_read_b128 v[76:79], v7 offset:64
    ds_read_b128 v[80:83], v7 offset:128
    ds_read_b128 v[84:87], v7 offset:192
    ds_read_b128 v[88:91], v7 offset:256
    ds_read_b128 v[92:95], v7 offset:320
    ds_read_b64_tr_b16 v[24:25], v6 offset:49408
    ds_read_b64_tr_b16 v[26:27], v6 offset:49664
    ds_read_b64_tr_b16 v[28:29], v6 offset:51456
    ds_read_b64_tr_b16 v[30:31], v6 offset:51712
    ds_read_b64_tr_b16 v[32:33], v6 offset:53504
    ds_read_b64_tr_b16 v[34:35], v6 offset:53760
    ds_read_b64_tr_b16 v[36:37], v6 offset:55552
    ds_read_b64_tr_b16 v[38:39], v6 offset:55808
    ds_read_b64_tr_b16 v[40:41], v6 offset:57600
    ds_read_b64_tr_b16 v[42:43], v6 offset:57856
    ds_read_b64_tr_b16 v[44:45], v6 offset:59648
    ds_read_b64_tr_b16 v[46:47], v6 offset:59904
    ds_read_b64_tr_b16 v[48:49], v6 offset:49440
    ds_read_b64_tr_b16 v[50:51], v6 offset:49696
    ds_read_b64_tr_b16 v[52:53], v6 offset:51488
    ds_read_b64_tr_b16 v[54:55], v6 offset:51744
    ds_read_b64_tr_b16 v[56:57], v6 offset:53536
    ds_read_b64_tr_b16 v[58:59], v6 offset:53792
    ds_read_b64_tr_b16 v[60:61], v6 offset:55584
    ds_read_b64_tr_b16 v[62:63], v6 offset:55840
    ds_read_b64_tr_b16 v[64:65], v6 offset:57632
    ds_read_b64_tr_b16 v[66:67], v6 offset:57888
    ds_read_b64_tr_b16 v[68:69], v6 offset:59680
    ds_read_b64_tr_b16 v[70:71], v6 offset:59936
    s_waitcnt lgkmcnt(0)
    v_mfma_f32_16x16x32_bf16 v[96:99], v[72:75], v[24:27], 0
    v_mfma_f32_16x16x32_bf16 v[100:103], v[72:75], v[48:51], 0
    v_mfma_f32_16x16x32_bf16 v[96:99], v[76:79], v[28:31], v[96:99]
    v_mfma_f32_16x16x32_bf16 v[100:103], v[76:79], v[52:55], v[100:103]
    v_mfma_f32_16x16x32_bf16 v[96:99], v[80:83], v[32:35], v[96:99]
    v_mfma_f32_16x16x32_bf16 v[100:103], v[80:83], v[56:59], v[100:103]
    v_mfma_f32_16x16x32_bf16 v[96:99], v[84:87], v[36:39], v[96:99]
    v_mfma_f32_16x16x32_bf16 v[100:103], v[84:87], v[60:63], v[100:103]
    v_mfma_f32_16x16x32_bf16 v[96:99], v[88:91], v[40:43], v[96:99]
    v_mfma_f32_16x16x32_bf16 v[100:103], v[88:91], v[64:67], v[100:103]
    v_mfma_f32_16x16x32_bf16 v[96:99], v[92:95], v[44:47], v[96:99]
    v_mfma_f32_16x16x32_bf16 v[100:103], v[92:95], v[68:71], v[100:103]
    s_mul_i32 s33, s30, 6144
    s_lshr_b32 s34, s28, 1
    s_lshl_b32 s34, s34, 10
    s_add_u32 s33, s33, s34
    s_and_b32 s34, s28, 1
    s_lshl_b32 s34, s34, 3
    s_add_u32 s33, s33, s34
    s_add_u32 s33, s33, 2097152
    v_lshl_add_u32 v5, v1, 4, s33
    v_cvt_pk_bf16_f32 v104, v96, v97
    v_cvt_pk_bf16_f32 v105, v98, v99
    v_cvt_pk_bf16_f32 v106, v100, v101
    v_cvt_pk_bf16_f32 v107, v102, v103
    global_store_dwordx2 v5, v[104:105], s[26:27] sc1
    global_store_dwordx2 v5, v[106:107], s[26:27] offset:3072 sc1
    s_waitcnt vmcnt(0)
L_wvo_d_46:
    s_barrier
    s_cmp_lg_u32 s28, 0
    s_cbranch_scc1 L_wvo_nf_47
    v_mov_b32 v4, 0
    s_mov_b32 s42, 0
    s_nop 1
L_poll_48:
    global_load_dword v10, v4, s[24:25] sc1
    s_add_u32 s42, s42, 1
    s_waitcnt vmcnt(0)
    v_cmp_eq_u32 vcc, 0, v10
    s_nop 4
    s_cbranch_vccz L_polld_49
    s_sleep 2
    s_cmp_lt_u32 s42, 0x40000
    s_cbranch_scc1 L_poll_48
L_polld_49:
    s_lshl_b32 s33, s30, 7
    s_add_u32 s33, s33, 2228224
    v_mov_b32 v4, s33
    s_mov_b64 exec, 1
    global_store_dword v4, v10, s[26:27] sc1
    s_mov_b64 exec, -1
L_wvo_nf_47:
L_end:
L_exit:
    s_endpgm
.section .rodata,"a"
.p2align 6
.amdhsa_kernel standalone__detection_seg_dino__vision_kernel
  .amdhsa_next_free_vgpr 256
  .amdhsa_next_free_sgpr 102
  .amdhsa_accum_offset 256
  .amdhsa_group_segment_fixed_size 0
  .amdhsa_kernarg_size 80
  .amdhsa_user_sgpr_count 2
  .amdhsa_user_sgpr_kernarg_segment_ptr 1
  .amdhsa_system_sgpr_workgroup_id_x 1
.end_amdhsa_kernel
```
